```python
import torch

def _softmax(x, axis=-1):
    return torch.softmax(x, dim=axis)
def _gelu(x):
    return torch.nn.functional.gelu(x, approximate="tanh")
def _silu(x):
    return torch.nn.functional.silu(x)
def _sigmoid(x):
    return torch.sigmoid(x)
def _layernorm(x, axis=-1, eps=1e-5):
    m = x.mean(dim=axis, keepdim=True)
    v = x.var(dim=axis, keepdim=True, unbiased=False)
    return (x - m) / torch.sqrt(v + eps)
def _scatter_add(tgt, idx, src, axis=0):
    return tgt.clone().index_add_(axis, idx, src)
def _segment_sum(src, seg, n):
    out = torch.zeros((n,) + src.shape[1:], dtype=src.dtype)
    return out.index_add_(0, seg, src)
def _pad(x, pw):
    flat = tuple(v for pair in reversed(pw) for v in pair)
    return torch.nn.functional.pad(x, flat)

kernel_name = 'gated_mix__sliding_block__mixer_channel_mlp__prompt'

def setup_inputs():

    _w = (lambda a: (lambda t: t.to(torch.bfloat16) if t.is_floating_point() else t)(torch.as_tensor(a)))
    def _A_setup():
        B, S, D = 1, 2048, 512
        return {
            "x": _w((lambda *s: torch.randn(*s, dtype=torch.bfloat16) * 0.05)(B, S, D)),
            "wqkv": _w((lambda *s: torch.randn(*s, dtype=torch.bfloat16) * 0.8)(D, 3 * D)),
            "wo": _w((lambda *s: torch.randn(*s, dtype=torch.bfloat16) * 0.05)(D, D)),
        }
    _A_in = _A_setup()

    def _B_setup():
        B, S, D, F = 1, 2048, 512, 1792
        return {
            "x": _w((lambda *s: torch.randn(*s, dtype=torch.bfloat16) * 0.05)(B, S, D)),
            "w1": _w((lambda *s: torch.randn(*s, dtype=torch.bfloat16) * 3.2)(D, F) * (D ** -0.5)),
            "b1": _w((lambda *s: torch.randn(*s, dtype=torch.bfloat16) * 1.6)(F)),
            "w2": _w((lambda *s: torch.randn(*s, dtype=torch.bfloat16) * 0.1)(F, D) * (F ** -0.5)),
            "b2": _w((lambda *s: torch.randn(*s, dtype=torch.bfloat16) * 0.2)(D)),
        }
    _B_in = _B_setup()

    return {
        "A_x": _A_in["x"],
        "A_wqkv": _A_in["wqkv"],
        "A_wo": _A_in["wo"],
        "B_x": _B_in["x"],
        "B_w1": _B_in["w1"],
        "B_b1": _B_in["b1"],
        "B_w2": _B_in["w2"],
        "B_b2": _B_in["b2"],
        "gate_w": _w((lambda *s: torch.randn(*s, dtype=torch.bfloat16) * 0.05)(512) * 16.0),
    }

def reference(A_x, A_wqkv, A_wo, B_x, B_w1, B_b1, B_w2, B_b2, gate_w):
    def _A_ref(x, wqkv, wo):
        B, S, D = x.shape
        H = 32; Dh = D // H; W = 256
        qkv = (lambda x, *d: x.permute(*d))((x @ wqkv).reshape(B, S, 3, H, Dh), 2, 0, 3, 1, 4)
        q, k, v = qkv[0], qkv[1], qkv[2]
        scores = torch.einsum("bhqd,bhkd->bhqk", q, k) * (Dh ** -0.5)
        idx = torch.arange(S)
        mask = (idx[:, None] - idx[None, :] >= 0) & (idx[:, None] - idx[None, :] < W)
        scores = torch.where(mask[None, None], scores, -1e9)
        p = _softmax(scores, axis=-1)
        o = torch.einsum("bhqk,bhkd->bhqd", p, v)
        return (lambda x, *d: x.permute(*d))(o, 0, 2, 1, 3).reshape(B, S, D) @ wo

    def _B_ref(x, w1, b1, w2, b2):
        y = _layernorm(x, axis=-1)
        h = _gelu(torch.einsum("bsd,df->bsf", y, w1) + b1)
        return torch.einsum("bsf,fd->bsd", h, w2) + b2

    x = A_x
    g = _sigmoid((x * gate_w).sum(-1, keepdims=True))
    a = _A_ref(x, A_wqkv, A_wo)
    b = _B_ref(x, B_w1, B_b1, B_w2, B_b2)
    return g * a + (1 - g) * b
```

```asm
; @launch grid=(256,1,1) block=(512,1,1) lds=163840
.amdgcn_target "amdgcn-amd-amdhsa--gfx950"
.text
.p2align 12
.globl gated_mix__sliding_block__mixer_channel_mlp__prompt_kernel
.p2align 8
.type gated_mix__sliding_block__mixer_channel_mlp__prompt_kernel,@function
gated_mix__sliding_block__mixer_channel_mlp__prompt_kernel:
    s_load_dwordx16 s[4:19], s[0:1], 0
    s_load_dwordx8 s[20:27], s[0:1], 64
    v_lshrrev_b32 v4, 6, v0
    s_cmp_ge_u32 s2, 256
    s_cbranch_scc1 L_end
    v_readfirstlane_b32 s52, v4
    v_and_b32 v1, 63, v0
    s_lshr_b32 s60, s2, 3
    s_lshr_b32 s61, s2, 6
    s_and_b32 s59, s2, 6
    s_lshl1_add_u32 s55, s59, s61
    s_lshl1_add_u32 s50, s61, s60
    s_and_b32 s50, s50, 7
    s_lshl_b32 s50, s50, 7
    s_and_b32 s59, s2, 1
    s_and_b32 s61, s60, 7
    s_lshl3_add_u32 s54, s59, s61
    s_and_b32 s53, s52, 3
    s_cmp_lt_u32 s52, 4
    s_cbranch_scc1 L_streamG
    s_getpc_b64 s[100:101]
L_pc:
    s_lshl2_add_u32 s59, s60, s53
    s_lshl_b32 s59, s59, 9
    v_lshl_add_u32 v4, v1, 7, s59
    v_min_u32 v4, L_end-L_pc, v4
    s_mov_b64 exec, 15
    global_load_dword v0, v4, s[100:101]
    s_mov_b64 exec, -1
    s_branch L_streamA
L_streamG:
    v_lshrrev_b32 v4, 3, v1
    v_lshrrev_b32 v5, 4, v1
    v_and_b32 v6, 7, v1
    s_lshl2_add_u32 s59, s54, s53
    s_lshl_b32 s59, s59, 15
    v_xor_b32 v7, v6, v5
    v_lshl_add_u32 v8, v4, 10, s59
    v_lshl_add_u32 v204, v7, 4, v8
    v_xor_b32 v205, 64, v204
    v_add_u32 v205, 7168, v205
    v_add_u32 v206, 14336, v204
    v_add_u32 v207, 14336, v205
    s_lshl_b32 s96, s53, 12
    s_lshl_b32 s72, s53, 11
    s_lshl_b32 s51, s53, 10
    s_mul_i32 s63, s53, 20
    s_and_b32 s63, s63, 36
    v_and_b32 v7, 4, v4
    v_add3_u32 v7, v7, v4, s63
    v_and_b32 v8, 6, v4
    v_xor_b32 v8, v8, v6
    v_lshlrev_b32 v8, 4, v8
    s_lshl_b32 s59, s55, 7
    v_mul_u32_u24 v208, 3072, v7
    v_add3_u32 v208, v208, v8, s59
    v_add_u32 v209, 48128, v208
    s_and_b32 s61, s55, 3
    s_mul_i32 s62, s55, 224
    s_lshl_b32 s59, s61, 5
    s_add_u32 s59, s59, s62
    v_mul_u32_u24 v211, 3584, v7
    v_add3_u32 v211, v211, v8, s59
    v_add_u32 v212, 56320, v211
    v_bfe_u32 v7, v1, 2, 2
    v_lshl_add_u32 v7, v5, 3, v7
    v_add_u32 v7, s63, v7
    v_and_b32 v8, 2, v4
    v_and_b32 v9, 3, v1
    v_xor_b32 v8, v8, v9
    v_lshlrev_b32 v8, 4, v8
    s_lshl_b32 s59, s55, 6
    s_addk_i32 s59, 2048
    v_mul_u32_u24 v210, 3072, v7
    v_add3_u32 v210, v210, v8, s59
    s_mov_b32 s30, 2097152
    s_mov_b32 s31, 0x20000
    s_mov_b32 s34, 1572864
    s_mov_b32 s35, 0x20000
    s_mov_b32 s90, 1835008
    s_mov_b32 s91, 0x20000
    s_waitcnt lgkmcnt(0)
    s_mov_b64 exec, 1
    global_load_dword v0, v204, s[4:5]
    global_load_dword v0, v208, s[6:7]
    global_load_dword v0, v211, s[12:13]
    s_mov_b64 exec, -1
    s_mov_b64 s[28:29], s[4:5]
    s_add_u32 m0, s96, 0
    s_add_u32 s48, s50, 0
    s_and_b32 s48, s48, 1023
    buffer_load_dwordx4 v204, s[28:31], s48 offen offset:0 lds
    buffer_load_dwordx4 v205, s[28:31], s48 offen offset:1024 lds
    buffer_load_dwordx4 v206, s[28:31], s48 offen offset:2048 lds
    buffer_load_dwordx4 v207, s[28:31], s48 offen offset:3072 lds
    s_mov_b64 s[32:33], s[6:7]
    s_add_u32 m0, s72, 49152
    s_mul_i32 s49, s48, 1536
    buffer_load_dwordx4 v208, s[32:35], s49 offen offset:0 lds
    buffer_load_dwordx4 v209, s[32:35], s49 offen offset:1024 lds
    s_add_u32 m0, s51, 57344
    s_nop 0
    buffer_load_dwordx4 v210, s[32:35], s49 offen lds
    s_mov_b64 s[88:89], s[12:13]
    s_add_u32 m0, s72, 86016
    s_mul_i32 s71, s48, 1792
    buffer_load_dwordx4 v211, s[88:91], s71 offen offset:0 lds
    buffer_load_dwordx4 v212, s[88:91], s71 offen offset:1024 lds
    v_lshlrev_b32 v2, 4, v1
    v_mov_b32 v3, 0
    s_mul_i32 s97, s53, 3072
    s_add_u32 s97, s97, 49152
    v_add_u32 v4, 0, v1
    v_mul_u32_u24 v5, 171, v4
    v_lshrrev_b32 v5, 10, v5
    v_mul_u32_u24 v6, 6, v5
    v_sub_u32 v6, v4, v6
    v_and_b32 v7, 0x23, v5
    v_lshrrev_b32 v8, 2, v5
    v_and_b32 v8, 3, v8
    v_lshl_add_u32 v7, v8, 3, v7
    v_lshrrev_b32 v8, 4, v5
    v_and_b32 v8, 1, v8
    v_lshl_add_u32 v7, v8, 2, v7
    v_mul_u32_u24 v7, 3584, v7
    v_lshl_add_u32 v7, v6, 4, v7
    v_lshrrev_b32 v6, 1, v6
    v_cmp_le_u32 vcc, s61, v6
    v_add_u32 v8, 128, v7
    s_nop 0
    v_cndmask_b32 v7, v7, v8, vcc
    s_sub_u32 s59, s62, 0
    v_add_u32 v213, s59, v7
    v_add_u32 v4, 64, v1
    v_mul_u32_u24 v5, 171, v4
    v_lshrrev_b32 v5, 10, v5
    v_mul_u32_u24 v6, 6, v5
    v_sub_u32 v6, v4, v6
    v_and_b32 v7, 0x23, v5
    v_lshrrev_b32 v8, 2, v5
    v_and_b32 v8, 3, v8
    v_lshl_add_u32 v7, v8, 3, v7
    v_lshrrev_b32 v8, 4, v5
    v_and_b32 v8, 1, v8
    v_lshl_add_u32 v7, v8, 2, v7
    v_mul_u32_u24 v7, 3584, v7
    v_lshl_add_u32 v7, v6, 4, v7
    v_lshrrev_b32 v6, 1, v6
    v_cmp_le_u32 vcc, s61, v6
    v_add_u32 v8, 128, v7
    s_nop 0
    v_cndmask_b32 v7, v7, v8, vcc
    s_sub_u32 s59, s62, 1024
    v_add_u32 v214, s59, v7
    v_add_u32 v4, 128, v1
    v_mul_u32_u24 v5, 171, v4
    v_lshrrev_b32 v5, 10, v5
    v_mul_u32_u24 v6, 6, v5
    v_sub_u32 v6, v4, v6
    v_and_b32 v7, 0x23, v5
    v_lshrrev_b32 v8, 2, v5
    v_and_b32 v8, 3, v8
    v_lshl_add_u32 v7, v8, 3, v7
    v_lshrrev_b32 v8, 4, v5
    v_and_b32 v8, 1, v8
    v_lshl_add_u32 v7, v8, 2, v7
    v_mul_u32_u24 v7, 3584, v7
    v_lshl_add_u32 v7, v6, 4, v7
    v_lshrrev_b32 v6, 1, v6
    v_cmp_le_u32 vcc, s61, v6
    v_add_u32 v8, 128, v7
    s_nop 0
    v_cndmask_b32 v7, v7, v8, vcc
    s_sub_u32 s59, s62, 2048
    v_add_u32 v215, s59, v7
    s_mov_b32 s36, s26
    s_mov_b32 s37, s27
    s_mov_b32 s38, 33554432
    s_mov_b32 s39, 0x20000
    s_or_b32 s59, s2, s52
    s_cmp_lg_u32 s59, 0
    s_cbranch_scc1 L_1
    s_memrealtime s[100:101]
    s_waitcnt lgkmcnt(0)
    s_or_b32 s59, s100, 1
    v_mov_b32 v4, s59
    global_store_dword v3, v4, s[24:25] sc1
L_1:
    v_lshrrev_b32 v220, 4, v1
    v_and_b32 v4, 15, v1
    v_lshrrev_b32 v5, 1, v4
    v_xor_b32 v5, v5, v220
    v_lshlrev_b32 v5, 4, v5
    v_lshl_add_u32 v5, v4, 7, v5
    s_lshl_b32 s59, s53, 12
    v_add_u32 v218, s59, v5
    v_xor_b32 v219, 64, v218
    v_lshrrev_b32 v6, 2, v1
    v_and_b32 v7, 3, v1
    v_lshlrev_b32 v7, 3, v7
    s_lshl_b32 s59, s54, 12
    s_lshl_b32 s60, s55, 8
    s_add_u32 s3, s59, s60
    s_add_u32 s3, s3, 22020096
    s_add_u32 s59, s3, 65536
    s_mov_b32 s87, 0
    s_atomic_add s87, s[26:27], s59 glc
    v_lshrrev_b32 v6, 2, v1
    v_and_b32 v7, 3, v1
    v_lshlrev_b32 v7, 3, v7
    v_mul_u32_u24 v19, 96, v6
    v_add_u32 v19, v19, v7
    v_add_u32 v20, 49152, v19
    v_lshl_add_u32 v8, v6, 7, v7
    v_and_b32 v9, 6, v6
    v_lshl_add_u32 v8, v9, 4, v8
    v_add_u32 v14, 86016, v8
    v_xor_b32 v15, 32, v14
    v_xor_b32 v16, 64, v14
    v_xor_b32 v17, 96, v14
    s_lshl_b32 s59, s53, 5
    v_xor_b32 v18, s59, v14
    v_lshlrev_b32 v4, 3, v220
    v_lshlrev_b32 v21, 4, v220
    v_add_u32 v21, 155904, v21
    v_mov_b32 v12, 156416
    v_mov_b32 v13, 1
    s_lshl_b32 s61, s54, 2
    s_add_u32 s61, s61, s53
    s_mul_i32 s61, s61, 144
    s_mul_i32 s60, s55, 7
    s_add_u32 s61, s61, s60
    s_mul_i32 s62, s55, 224
    s_and_b32 s63, s55, 3
    s_add_u32 s63, s63, 0
    s_lshl_b32 s59, s63, 5
    s_add_u32 s60, s59, 156672
    v_add_u32 v24, s60, v4
    s_add_u32 s63, s63, s61
    s_lshl_b32 s63, s63, 10
    s_add_u32 s64, s63, 8388608
    s_and_b32 s63, s55, 3
    s_add_u32 s63, s63, 1
    s_lshl_b32 s59, s63, 5
    s_add_u32 s60, s59, 156672
    v_add_u32 v25, s60, v4
    s_add_u32 s63, s63, s61
    s_lshl_b32 s63, s63, 10
    s_add_u32 s65, s63, 8388608
    s_and_b32 s63, s55, 3
    s_add_u32 s63, s63, 2
    s_lshl_b32 s59, s63, 5
    s_add_u32 s60, s59, 156672
    v_add_u32 v26, s60, v4
    s_add_u32 s63, s63, s61
    s_lshl_b32 s63, s63, 10
    s_add_u32 s66, s63, 8388608
    s_and_b32 s63, s55, 3
    s_add_u32 s63, s63, 3
    s_lshl_b32 s59, s63, 5
    s_add_u32 s60, s59, 156672
    v_add_u32 v27, s60, v4
    s_add_u32 s63, s63, s61
    s_lshl_b32 s63, s63, 10
    s_add_u32 s67, s63, 8388608
    s_and_b32 s63, s55, 3
    s_cmp_gt_u32 s63, 0
    s_cselect_b32 s63, 0, 4
    s_lshl_b32 s59, s63, 5
    s_add_u32 s60, s59, 156672
    v_add_u32 v28, s60, v4
    s_add_u32 s63, s63, s61
    s_lshl_b32 s63, s63, 10
    s_add_u32 s68, s63, 8388608
    s_and_b32 s63, s55, 3
    s_cmp_gt_u32 s63, 1
    s_cselect_b32 s63, 1, 5
    s_lshl_b32 s59, s63, 5
    s_add_u32 s60, s59, 156672
    v_add_u32 v29, s60, v4
    s_add_u32 s63, s63, s61
    s_lshl_b32 s63, s63, 10
    s_add_u32 s69, s63, 8388608
    s_and_b32 s63, s55, 3
    s_cmp_gt_u32 s63, 2
    s_cselect_b32 s63, 2, 6
    s_lshl_b32 s59, s63, 5
    s_add_u32 s60, s59, 156672
    v_add_u32 v30, s60, v4
    s_add_u32 s63, s63, s61
    s_lshl_b32 s63, s63, 10
    s_add_u32 s70, s63, 8388608
    v_and_b32 v4, 15, v1
    s_lshl_b32 s59, s53, 9
    s_add_u32 s59, s59, 153856
    v_lshlrev_b32 v4, 4, v4
    v_add_u32 v22, s59, v4
    v_mov_b32 v240, 0x3f803f80
    v_mov_b32 v241, 0x3f803f80
    v_mov_b32 v242, 0x3f803f80
    v_mov_b32 v243, 0x3f803f80
    v_mov_b32 v32, 3222493025
    v_mov_b32 v33, 3184710632
    s_mov_b32 s40, s16
    s_mov_b32 s41, s17
    s_mov_b32 s42, 1835008
    s_mov_b32 s43, 0x20000
    s_mov_b32 s44, s8
    s_mov_b32 s45, s9
    s_mov_b32 s46, 524288
    s_mov_b32 s47, 0x20000
    s_lshr_b32 s60, s2, 3
    s_and_b32 s59, s2, 6
    s_and_b32 s61, s60, 7
    s_lshl2_add_u32 s56, s59, s61
    s_and_b32 s59, s2, 1
    s_lshr_b32 s60, s60, 3
    s_lshl2_add_u32 s57, s59, s60
    v_lshrrev_b32 v5, 3, v1
    v_and_b32 v4, 6, v5
    v_and_b32 v6, 7, v1
    v_xor_b32 v4, v4, v6
    v_lshlrev_b32 v4, 4, v4
    s_lshl_b32 s59, s57, 7
    v_add_u32 v4, s59, v4
    v_and_b32 v6, 4, v5
    s_mul_i32 s59, s53, 448
    v_add3_u32 v6, v6, v5, s59
    v_lshl_add_u32 v10, v6, 10, v4
    v_add_u32 v11, 3072, v10
    s_lshl_b32 s98, s53, 11
    s_bfe_u32 s59, s2, 0x10001
    s_and_b32 s86, s56, 3
    s_lshl1_add_u32 s86, s86, s59
    s_mul_i32 s60, s86, 7
    s_lshr_b32 s60, s60, 2
    s_lshl_b32 s84, s60, 15
    s_lshl_b32 s85, s60, 11
    s_and_b32 s86, s86, 6
    s_add_u32 s84, s84, 131072
    s_cmp_lt_u32 s84, 458752
    s_cselect_b32 s59, 0, 458752
    s_sub_u32 s84, s84, s59
    s_add_u32 s59, s56, s2
    s_and_b32 s59, s59, 3
    s_lshl_b32 s60, s52, 2
    s_add_u32 s59, s59, s60
    s_lshl_b32 s61, s57, 7
    s_mul_i32 s60, s59, 114688
    s_add_u32 s60, s60, s61
    v_lshlrev_b32 v4, 10, v1
    v_add_u32 v216, s60, v4
    s_lshl_b32 s60, s59, 15
    s_add_u32 s60, s60, s61
    v_add_u32 v217, s60, v4
    s_lshr_b32 s73, s2, 3
    s_mul_i32 s73, s73, 0
    s_lshr_b32 s73, s73, 5
    s_add_u32 m0, s96, 16384
    s_add_u32 s48, s50, 128
    s_and_b32 s48, s48, 1023
    buffer_load_dwordx4 v204, s[28:31], s48 offen offset:0 lds
    buffer_load_dwordx4 v205, s[28:31], s48 offen offset:1024 lds
    buffer_load_dwordx4 v206, s[28:31], s48 offen offset:2048 lds
    buffer_load_dwordx4 v207, s[28:31], s48 offen offset:3072 lds
    s_add_u32 m0, s72, 61440
    s_mul_i32 s49, s48, 1536
    buffer_load_dwordx4 v208, s[32:35], s49 offen offset:0 lds
    buffer_load_dwordx4 v209, s[32:35], s49 offen offset:1024 lds
    s_add_u32 m0, s51, 69632
    s_nop 0
    buffer_load_dwordx4 v210, s[32:35], s49 offen lds
    s_add_u32 m0, s72, 94208
    s_mul_i32 s71, s48, 1792
    buffer_load_dwordx4 v211, s[88:91], s71 offen offset:0 lds
    buffer_load_dwordx4 v212, s[88:91], s71 offen offset:1024 lds
    s_waitcnt vmcnt(11)
    s_barrier
    ds_read_b128 v[36:39], v218 offset:0
    ds_read_b128 v[40:43], v218 offset:2048
    ds_read_b128 v[44:47], v219 offset:0
    ds_read_b128 v[48:51], v219 offset:2048
    s_add_u32 m0, s96, 32768
    s_add_u32 s48, s50, 256
    s_and_b32 s48, s48, 1023
    buffer_load_dwordx4 v204, s[28:31], s48 offen offset:0 lds
    buffer_load_dwordx4 v205, s[28:31], s48 offen offset:1024 lds
    buffer_load_dwordx4 v206, s[28:31], s48 offen offset:2048 lds
    buffer_load_dwordx4 v207, s[28:31], s48 offen offset:3072 lds
    s_add_u32 m0, s72, 73728
    s_mul_i32 s49, s48, 1536
    buffer_load_dwordx4 v208, s[32:35], s49 offen offset:0 lds
    buffer_load_dwordx4 v209, s[32:35], s49 offen offset:1024 lds
    s_add_u32 m0, s51, 81920
    s_nop 0
    buffer_load_dwordx4 v210, s[32:35], s49 offen lds
    s_add_u32 m0, s72, 102400
    s_mul_i32 s71, s48, 1792
    buffer_load_dwordx4 v211, s[88:91], s71 offen offset:0 lds
    buffer_load_dwordx4 v212, s[88:91], s71 offen offset:1024 lds
    s_setprio 2
    s_waitcnt vmcnt(9)
    s_waitcnt lgkmcnt(0)
    s_barrier
    ds_read_b128 v[52:55], v218 offset:16384
    ds_read_b128 v[56:59], v218 offset:18432
    ds_read_b128 v[60:63], v219 offset:16384
    ds_read_b128 v[64:67], v219 offset:18432
    ds_read_b64_tr_b16 v[164:165], v18 offset:0
    ds_read_b64_tr_b16 v[166:167], v18 offset:2048
    ds_read_b64_tr_b16 v[168:169], v18 offset:4096
    ds_read_b64_tr_b16 v[170:171], v18 offset:6144
    ds_read_b64_tr_b16 v[172:173], v18 offset:8192
    ds_read_b64_tr_b16 v[174:175], v18 offset:10240
    ds_read_b64_tr_b16 v[176:177], v18 offset:12288
    ds_read_b64_tr_b16 v[178:179], v18 offset:14336
    s_add_u32 m0, s96, 0
    s_add_u32 s48, s50, 384
    s_and_b32 s48, s48, 1023
    buffer_load_dwordx4 v204, s[28:31], s48 offen offset:0 lds
    buffer_load_dwordx4 v205, s[28:31], s48 offen offset:1024 lds
    buffer_load_dwordx4 v206, s[28:31], s48 offen offset:2048 lds
    buffer_load_dwordx4 v207, s[28:31], s48 offen offset:3072 lds
    s_add_u32 m0, s72, 49152
    s_mul_i32 s49, s48, 1536
    buffer_load_dwordx4 v208, s[32:35], s49 offen offset:0 lds
    buffer_load_dwordx4 v209, s[32:35], s49 offen offset:1024 lds
    s_add_u32 m0, s51, 57344
    s_nop 0
    buffer_load_dwordx4 v210, s[32:35], s49 offen lds
    s_add_u32 m0, s72, 110592
    s_mul_i32 s71, s48, 1792
    buffer_load_dwordx4 v211, s[88:91], s71 offen offset:0 lds
    buffer_load_dwordx4 v212, s[88:91], s71 offen offset:1024 lds
    s_waitcnt vmcnt(9)
    s_waitcnt lgkmcnt(0)
    s_barrier
    ds_read_b128 v[68:71], v218 offset:32768
    ds_read_b128 v[72:75], v218 offset:34816
    ds_read_b128 v[76:79], v219 offset:32768
    ds_read_b128 v[80:83], v219 offset:34816
    v_mfma_f32_16x16x32_bf16 v[236:239], v[164:167], v[240:243], 0
    v_mfma_f32_16x16x32_bf16 v[236:239], v[168:171], v[240:243], v[236:239]
    v_mfma_f32_16x16x32_bf16 v[236:239], v[172:175], v[240:243], v[236:239]
    v_mfma_f32_16x16x32_bf16 v[236:239], v[176:179], v[240:243], v[236:239]
    ds_read_b64_tr_b16 v[180:181], v18 offset:16384
    ds_read_b64_tr_b16 v[182:183], v18 offset:18432
    ds_read_b64_tr_b16 v[184:185], v18 offset:20480
    ds_read_b64_tr_b16 v[186:187], v18 offset:22528
    s_add_u32 m0, s96, 16384
    s_add_u32 s48, s50, 512
    s_and_b32 s48, s48, 1023
    buffer_load_dwordx4 v204, s[28:31], s48 offen offset:0 lds
    buffer_load_dwordx4 v205, s[28:31], s48 offen offset:1024 lds
    buffer_load_dwordx4 v206, s[28:31], s48 offen offset:2048 lds
    buffer_load_dwordx4 v207, s[28:31], s48 offen offset:3072 lds
    s_add_u32 m0, s72, 61440
    s_mul_i32 s49, s48, 1536
    buffer_load_dwordx4 v208, s[32:35], s49 offen offset:0 lds
    buffer_load_dwordx4 v209, s[32:35], s49 offen offset:1024 lds
    s_add_u32 m0, s51, 69632
    s_nop 0
    buffer_load_dwordx4 v210, s[32:35], s49 offen lds
    s_add_u32 m0, s72, 118784
    s_mul_i32 s71, s48, 1792
    buffer_load_dwordx4 v211, s[88:91], s71 offen offset:0 lds
    buffer_load_dwordx4 v212, s[88:91], s71 offen offset:1024 lds
    s_waitcnt vmcnt(9)
    s_waitcnt lgkmcnt(0)
    s_barrier
    ds_read_b128 v[84:87], v218 offset:0
    ds_read_b128 v[88:91], v218 offset:2048
    ds_read_b128 v[92:95], v219 offset:0
    ds_read_b128 v[96:99], v219 offset:2048
    v_mfma_f32_16x16x32_bf16 v[236:239], v[180:183], v[240:243], v[236:239]
    v_mfma_f32_16x16x32_bf16 v[236:239], v[184:187], v[240:243], v[236:239]
    ds_read_b64_tr_b16 v[164:165], v18 offset:24576
    ds_read_b64_tr_b16 v[166:167], v18 offset:26624
    ds_read_b64_tr_b16 v[168:169], v18 offset:28672
    ds_read_b64_tr_b16 v[170:171], v18 offset:30720
    s_add_u32 m0, s96, 32768
    s_add_u32 s48, s50, 640
    s_and_b32 s48, s48, 1023
    buffer_load_dwordx4 v204, s[28:31], s48 offen offset:0 lds
    buffer_load_dwordx4 v205, s[28:31], s48 offen offset:1024 lds
    buffer_load_dwordx4 v206, s[28:31], s48 offen offset:2048 lds
    buffer_load_dwordx4 v207, s[28:31], s48 offen offset:3072 lds
    s_add_u32 m0, s72, 73728
    s_mul_i32 s49, s48, 1536
    buffer_load_dwordx4 v208, s[32:35], s49 offen offset:0 lds
    buffer_load_dwordx4 v209, s[32:35], s49 offen offset:1024 lds
    s_add_u32 m0, s51, 81920
    s_nop 0
    buffer_load_dwordx4 v210, s[32:35], s49 offen lds
    s_add_u32 m0, s72, 126976
    s_mul_i32 s71, s48, 1792
    buffer_load_dwordx4 v211, s[88:91], s71 offen offset:0 lds
    buffer_load_dwordx4 v212, s[88:91], s71 offen offset:1024 lds
    s_waitcnt vmcnt(9)
    s_waitcnt lgkmcnt(0)
    s_barrier
    ds_read_b128 v[100:103], v218 offset:16384
    ds_read_b128 v[104:107], v218 offset:18432
    ds_read_b128 v[108:111], v219 offset:16384
    ds_read_b128 v[112:115], v219 offset:18432
    v_mfma_f32_16x16x32_bf16 v[236:239], v[164:167], v[240:243], v[236:239]
    v_mfma_f32_16x16x32_bf16 v[236:239], v[168:171], v[240:243], v[236:239]
    ds_read_b64_tr_b16 v[172:173], v18 offset:32768
    ds_read_b64_tr_b16 v[174:175], v18 offset:34816
    ds_read_b64_tr_b16 v[176:177], v18 offset:36864
    ds_read_b64_tr_b16 v[178:179], v18 offset:38912
    s_add_u32 m0, s96, 0
    s_add_u32 s48, s50, 768
    s_and_b32 s48, s48, 1023
    buffer_load_dwordx4 v204, s[28:31], s48 offen offset:0 nt lds
    buffer_load_dwordx4 v205, s[28:31], s48 offen offset:1024 nt lds
    buffer_load_dwordx4 v206, s[28:31], s48 offen offset:2048 nt lds
    buffer_load_dwordx4 v207, s[28:31], s48 offen offset:3072 nt lds
    s_add_u32 m0, s72, 49152
    s_mul_i32 s49, s48, 1536
    buffer_load_dwordx4 v208, s[32:35], s49 offen offset:0 lds
    buffer_load_dwordx4 v209, s[32:35], s49 offen offset:1024 lds
    s_add_u32 m0, s51, 57344
    s_nop 0
    buffer_load_dwordx4 v210, s[32:35], s49 offen lds
    s_add_u32 m0, s72, 135168
    s_mul_i32 s71, s48, 1792
    buffer_load_dwordx4 v211, s[88:91], s71 offen offset:0 lds
    buffer_load_dwordx4 v212, s[88:91], s71 offen offset:1024 lds
    s_waitcnt vmcnt(9)
    s_waitcnt lgkmcnt(0)
    s_barrier
    ds_read_b128 v[116:119], v218 offset:32768
    ds_read_b128 v[120:123], v218 offset:34816
    ds_read_b128 v[124:127], v219 offset:32768
    ds_read_b128 v[128:131], v219 offset:34816
    v_mfma_f32_16x16x32_bf16 v[236:239], v[172:175], v[240:243], v[236:239]
    v_mfma_f32_16x16x32_bf16 v[236:239], v[176:179], v[240:243], v[236:239]
    ds_read_b64_tr_b16 v[180:181], v18 offset:40960
    ds_read_b64_tr_b16 v[182:183], v18 offset:43008
    ds_read_b64_tr_b16 v[184:185], v18 offset:45056
    ds_read_b64_tr_b16 v[186:187], v18 offset:47104
    s_add_u32 m0, s96, 16384
    s_add_u32 s48, s50, 896
    s_and_b32 s48, s48, 1023
    buffer_load_dwordx4 v204, s[28:31], s48 offen offset:0 nt lds
    buffer_load_dwordx4 v205, s[28:31], s48 offen offset:1024 nt lds
    buffer_load_dwordx4 v206, s[28:31], s48 offen offset:2048 nt lds
    buffer_load_dwordx4 v207, s[28:31], s48 offen offset:3072 nt lds
    s_add_u32 m0, s72, 61440
    s_mul_i32 s49, s48, 1536
    buffer_load_dwordx4 v208, s[32:35], s49 offen offset:0 nt lds
    buffer_load_dwordx4 v209, s[32:35], s49 offen offset:1024 nt lds
    s_add_u32 m0, s51, 69632
    s_nop 0
    buffer_load_dwordx4 v210, s[32:35], s49 offen nt lds
    s_add_u32 m0, s72, 143360
    s_mul_i32 s71, s48, 1792
    buffer_load_dwordx4 v211, s[88:91], s71 offen offset:0 nt lds
    buffer_load_dwordx4 v212, s[88:91], s71 offen offset:1024 nt lds
    s_waitcnt vmcnt(9)
    s_waitcnt lgkmcnt(0)
    s_barrier
    ds_read_b128 v[132:135], v218 offset:0
    ds_read_b128 v[136:139], v218 offset:2048
    ds_read_b128 v[140:143], v219 offset:0
    ds_read_b128 v[144:147], v219 offset:2048
    v_mfma_f32_16x16x32_bf16 v[236:239], v[180:183], v[240:243], v[236:239]
    v_mfma_f32_16x16x32_bf16 v[236:239], v[184:187], v[240:243], v[236:239]
    ds_read_b64_tr_b16 v[164:165], v18 offset:49152
    ds_read_b64_tr_b16 v[166:167], v18 offset:51200
    ds_read_b64_tr_b16 v[168:169], v18 offset:53248
    ds_read_b64_tr_b16 v[170:171], v18 offset:55296
    s_cmp_lg_u32 s52, 3
    s_cbranch_scc1 L_2
    s_mov_b32 m0, 156928
    s_mul_i32 s59, s55, 224
    global_load_lds_dwordx4 v2, s[18:19]
    v_lshl_add_u32 v4, v1, 2, s59
    s_mov_b32 m0, 156672
    s_mov_b32 exec_hi, 0xffffff
    global_load_lds_dword v4, s[14:15]
    s_mov_b64 exec, -1
L_2:
    global_load_dword v23, v3, s[24:25] sc1
    s_add_u32 m0, s97, 4294950912
    s_lshl_b32 s59, s53, 6
    s_add_u32 s59, s59, s50
    s_add_u32 s59, s59, 0
    s_and_b32 s59, s59, 1023
    s_mul_i32 s71, s59, 1792
    buffer_load_dwordx4 v213, s[88:91], s71 offen offset:0 lds
    buffer_load_dwordx4 v214, s[88:91], s71 offen offset:1024 lds
    buffer_load_dwordx4 v215, s[88:91], s71 offen offset:2048 lds
    s_add_u32 m0, s97, 24576
    s_lshl_b32 s59, s53, 6
    s_add_u32 s59, s59, s50
    s_add_u32 s59, s59, 256
    s_and_b32 s59, s59, 1023
    s_mul_i32 s71, s59, 1792
    buffer_load_dwordx4 v213, s[88:91], s71 offen offset:0 lds
    buffer_load_dwordx4 v214, s[88:91], s71 offen offset:1024 lds
    buffer_load_dwordx4 v215, s[88:91], s71 offen offset:2048 lds
    s_waitcnt vmcnt(7)
    s_waitcnt lgkmcnt(0)
    s_barrier
    ds_read_b128 v[148:151], v218 offset:16384
    ds_read_b128 v[152:155], v218 offset:18432
    ds_read_b128 v[156:159], v219 offset:16384
    ds_read_b128 v[160:163], v219 offset:18432
    v_mfma_f32_16x16x32_bf16 v[236:239], v[164:167], v[240:243], v[236:239]
    v_mfma_f32_16x16x32_bf16 v[236:239], v[168:171], v[240:243], v[236:239]
    ds_read_b64_tr_b16 v[172:173], v18 offset:57344
    ds_read_b64_tr_b16 v[174:175], v18 offset:59392
    ds_read_b64_tr_b16 v[176:177], v18 offset:61440
    ds_read_b64_tr_b16 v[178:179], v18 offset:63488
    s_add_u32 m0, s97, 4294918144
    s_lshl_b32 s59, s53, 6
    s_add_u32 s59, s59, s50
    s_add_u32 s59, s59, 512
    s_and_b32 s59, s59, 1023
    s_mul_i32 s71, s59, 1792
    buffer_load_dwordx4 v213, s[88:91], s71 offen offset:0 lds
    buffer_load_dwordx4 v214, s[88:91], s71 offen offset:1024 lds
    buffer_load_dwordx4 v215, s[88:91], s71 offen offset:2048 lds
    s_add_u32 m0, s97, 0
    s_lshl_b32 s59, s53, 6
    s_add_u32 s59, s59, s50
    s_add_u32 s59, s59, 768
    s_and_b32 s59, s59, 1023
    s_mul_i32 s71, s59, 1792
    buffer_load_dwordx4 v213, s[88:91], s71 offen offset:0 lds
    buffer_load_dwordx4 v214, s[88:91], s71 offen offset:1024 lds
    buffer_load_dwordx4 v215, s[88:91], s71 offen offset:2048 lds
    s_waitcnt lgkmcnt(0)
    v_mfma_f32_16x16x32_bf16 v[236:239], v[172:175], v[240:243], v[236:239]
    v_mfma_f32_16x16x32_bf16 v[236:239], v[176:179], v[240:243], v[236:239]
    s_setprio 0
    ds_read_b64_tr_b16 v[180:181], v14 offset:0
    ds_read_b64_tr_b16 v[182:183], v14 offset:2048
    ds_read_b64_tr_b16 v[184:185], v14 offset:4096
    ds_read_b64_tr_b16 v[186:187], v14 offset:6144
    ds_read_b64_tr_b16 v[164:165], v14 offset:8192
    ds_read_b64_tr_b16 v[166:167], v14 offset:10240
    ds_read_b64_tr_b16 v[168:169], v14 offset:12288
    ds_read_b64_tr_b16 v[170:171], v14 offset:14336
    s_waitcnt lgkmcnt(4)
    v_mfma_f32_16x16x32_bf16 v[188:191], v[180:183], v[36:39], 0
    ds_read_b64_tr_b16 v[172:173], v14 offset:16384
    v_mfma_f32_16x16x32_bf16 v[192:195], v[180:183], v[40:43], 0
    ds_read_b64_tr_b16 v[174:175], v14 offset:18432
    v_mfma_f32_16x16x32_bf16 v[188:191], v[184:187], v[44:47], v[188:191]
    ds_read_b64_tr_b16 v[176:177], v14 offset:20480
    v_mfma_f32_16x16x32_bf16 v[192:195], v[184:187], v[48:51], v[192:195]
    ds_read_b64_tr_b16 v[178:179], v14 offset:22528
    s_waitcnt lgkmcnt(4)
    v_mfma_f32_16x16x32_bf16 v[188:191], v[164:167], v[52:55], v[188:191]
    ds_read_b64_tr_b16 v[180:181], v14 offset:24576
    v_mfma_f32_16x16x32_bf16 v[192:195], v[164:167], v[56:59], v[192:195]
    ds_read_b64_tr_b16 v[182:183], v14 offset:26624
    v_mfma_f32_16x16x32_bf16 v[188:191], v[168:171], v[60:63], v[188:191]
    ds_read_b64_tr_b16 v[184:185], v14 offset:28672
    v_mfma_f32_16x16x32_bf16 v[192:195], v[168:171], v[64:67], v[192:195]
    ds_read_b64_tr_b16 v[186:187], v14 offset:30720
    s_waitcnt lgkmcnt(4)
    v_mfma_f32_16x16x32_bf16 v[188:191], v[172:175], v[68:71], v[188:191]
    ds_read_b64_tr_b16 v[164:165], v14 offset:32768
    v_mfma_f32_16x16x32_bf16 v[192:195], v[172:175], v[72:75], v[192:195]
    ds_read_b64_tr_b16 v[166:167], v14 offset:34816
    v_mfma_f32_16x16x32_bf16 v[188:191], v[176:179], v[76:79], v[188:191]
    ds_read_b64_tr_b16 v[168:169], v14 offset:36864
    v_mfma_f32_16x16x32_bf16 v[192:195], v[176:179], v[80:83], v[192:195]
    ds_read_b64_tr_b16 v[170:171], v14 offset:38912
    s_waitcnt lgkmcnt(4)
    v_mfma_f32_16x16x32_bf16 v[188:191], v[180:183], v[84:87], v[188:191]
    ds_read_b64_tr_b16 v[172:173], v14 offset:40960
    v_mfma_f32_16x16x32_bf16 v[192:195], v[180:183], v[88:91], v[192:195]
    ds_read_b64_tr_b16 v[174:175], v14 offset:43008
    v_mfma_f32_16x16x32_bf16 v[188:191], v[184:187], v[92:95], v[188:191]
    ds_read_b64_tr_b16 v[176:177], v14 offset:45056
    v_mfma_f32_16x16x32_bf16 v[192:195], v[184:187], v[96:99], v[192:195]
    ds_read_b64_tr_b16 v[178:179], v14 offset:47104
    s_waitcnt lgkmcnt(4)
    v_mfma_f32_16x16x32_bf16 v[188:191], v[164:167], v[100:103], v[188:191]
    ds_read_b64_tr_b16 v[180:181], v14 offset:49152
    v_mfma_f32_16x16x32_bf16 v[192:195], v[164:167], v[104:107], v[192:195]
    ds_read_b64_tr_b16 v[182:183], v14 offset:51200
    v_mfma_f32_16x16x32_bf16 v[188:191], v[168:171], v[108:111], v[188:191]
    ds_read_b64_tr_b16 v[184:185], v14 offset:53248
    v_mfma_f32_16x16x32_bf16 v[192:195], v[168:171], v[112:115], v[192:195]
    ds_read_b64_tr_b16 v[186:187], v14 offset:55296
    s_waitcnt lgkmcnt(4)
    v_mfma_f32_16x16x32_bf16 v[188:191], v[172:175], v[116:119], v[188:191]
    ds_read_b64_tr_b16 v[164:165], v14 offset:57344
    v_mfma_f32_16x16x32_bf16 v[192:195], v[172:175], v[120:123], v[192:195]
    ds_read_b64_tr_b16 v[166:167], v14 offset:59392
    v_mfma_f32_16x16x32_bf16 v[188:191], v[176:179], v[124:127], v[188:191]
    ds_read_b64_tr_b16 v[168:169], v14 offset:61440
    v_mfma_f32_16x16x32_bf16 v[192:195], v[176:179], v[128:131], v[192:195]
    ds_read_b64_tr_b16 v[170:171], v14 offset:63488
    s_waitcnt lgkmcnt(4)
    v_mfma_f32_16x16x32_bf16 v[188:191], v[180:183], v[132:135], v[188:191]
    ds_read_b64_tr_b16 v[172:173], v15 offset:0
    v_mfma_f32_16x16x32_bf16 v[192:195], v[180:183], v[136:139], v[192:195]
    ds_read_b64_tr_b16 v[174:175], v15 offset:2048
    v_mfma_f32_16x16x32_bf16 v[188:191], v[184:187], v[140:143], v[188:191]
    ds_read_b64_tr_b16 v[176:177], v15 offset:4096
    v_mfma_f32_16x16x32_bf16 v[192:195], v[184:187], v[144:147], v[192:195]
    ds_read_b64_tr_b16 v[178:179], v15 offset:6144
    s_waitcnt lgkmcnt(4)
    v_mfma_f32_16x16x32_bf16 v[188:191], v[164:167], v[148:151], v[188:191]
    ds_read_b64_tr_b16 v[180:181], v15 offset:8192
    v_mfma_f32_16x16x32_bf16 v[192:195], v[164:167], v[152:155], v[192:195]
    ds_read_b64_tr_b16 v[182:183], v15 offset:10240
    v_mfma_f32_16x16x32_bf16 v[188:191], v[168:171], v[156:159], v[188:191]
    ds_read_b64_tr_b16 v[184:185], v15 offset:12288
    v_mfma_f32_16x16x32_bf16 v[192:195], v[168:171], v[160:163], v[192:195]
    ds_read_b64_tr_b16 v[186:187], v15 offset:14336
    s_lshl_b32 s59, s53, 6
    v_add_u32 v4, s59, v21
    s_mov_b32 exec_lo, 0x00010001
    s_mov_b32 exec_hi, 0x00010001
    ds_write_b128 v4, v[236:239]
    s_mov_b64 exec, -1
    s_waitcnt lgkmcnt(5)
    v_mfma_f32_16x16x32_bf16 v[196:199], v[172:175], v[36:39], 0
    ds_read_b64_tr_b16 v[164:165], v15 offset:16384
    v_mfma_f32_16x16x32_bf16 v[200:203], v[172:175], v[40:43], 0
    ds_read_b64_tr_b16 v[166:167], v15 offset:18432
    v_mfma_f32_16x16x32_bf16 v[196:199], v[176:179], v[44:47], v[196:199]
    ds_read_b64_tr_b16 v[168:169], v15 offset:20480
    v_mfma_f32_16x16x32_bf16 v[200:203], v[176:179], v[48:51], v[200:203]
    ds_read_b64_tr_b16 v[170:171], v15 offset:22528
    s_waitcnt lgkmcnt(5)
    v_mfma_f32_16x16x32_bf16 v[196:199], v[180:183], v[52:55], v[196:199]
    ds_read_b64_tr_b16 v[172:173], v15 offset:24576
    v_mfma_f32_16x16x32_bf16 v[200:203], v[180:183], v[56:59], v[200:203]
    ds_read_b64_tr_b16 v[174:175], v15 offset:26624
    v_mfma_f32_16x16x32_bf16 v[196:199], v[184:187], v[60:63], v[196:199]
    ds_read_b64_tr_b16 v[176:177], v15 offset:28672
    v_mfma_f32_16x16x32_bf16 v[200:203], v[184:187], v[64:67], v[200:203]
    ds_read_b64_tr_b16 v[178:179], v15 offset:30720
    s_waitcnt lgkmcnt(4)
    v_mfma_f32_16x16x32_bf16 v[196:199], v[164:167], v[68:71], v[196:199]
    ds_read_b64_tr_b16 v[180:181], v15 offset:32768
    v_mfma_f32_16x16x32_bf16 v[200:203], v[164:167], v[72:75], v[200:203]
    ds_read_b64_tr_b16 v[182:183], v15 offset:34816
    v_mfma_f32_16x16x32_bf16 v[196:199], v[168:171], v[76:79], v[196:199]
    ds_read_b64_tr_b16 v[184:185], v15 offset:36864
    v_mfma_f32_16x16x32_bf16 v[200:203], v[168:171], v[80:83], v[200:203]
    ds_read_b64_tr_b16 v[186:187], v15 offset:38912
    s_waitcnt lgkmcnt(4)
    v_mfma_f32_16x16x32_bf16 v[196:199], v[172:175], v[84:87], v[196:199]
    ds_read_b64_tr_b16 v[164:165], v15 offset:40960
    v_mfma_f32_16x16x32_bf16 v[200:203], v[172:175], v[88:91], v[200:203]
    ds_read_b64_tr_b16 v[166:167], v15 offset:43008
    v_mfma_f32_16x16x32_bf16 v[196:199], v[176:179], v[92:95], v[196:199]
    ds_read_b64_tr_b16 v[168:169], v15 offset:45056
    v_mfma_f32_16x16x32_bf16 v[200:203], v[176:179], v[96:99], v[200:203]
    ds_read_b64_tr_b16 v[170:171], v15 offset:47104
    s_waitcnt lgkmcnt(4)
    v_mfma_f32_16x16x32_bf16 v[196:199], v[180:183], v[100:103], v[196:199]
    ds_read_b64_tr_b16 v[172:173], v15 offset:49152
    v_mfma_f32_16x16x32_bf16 v[200:203], v[180:183], v[104:107], v[200:203]
    ds_read_b64_tr_b16 v[174:175], v15 offset:51200
    v_mfma_f32_16x16x32_bf16 v[196:199], v[184:187], v[108:111], v[196:199]
    ds_read_b64_tr_b16 v[176:177], v15 offset:53248
    v_mfma_f32_16x16x32_bf16 v[200:203], v[184:187], v[112:115], v[200:203]
    ds_read_b64_tr_b16 v[178:179], v15 offset:55296
    s_waitcnt lgkmcnt(4)
    v_mfma_f32_16x16x32_bf16 v[196:199], v[164:167], v[116:119], v[196:199]
    ds_read_b64_tr_b16 v[180:181], v15 offset:57344
    v_mfma_f32_16x16x32_bf16 v[200:203], v[164:167], v[120:123], v[200:203]
    ds_read_b64_tr_b16 v[182:183], v15 offset:59392
    v_mfma_f32_16x16x32_bf16 v[196:199], v[168:171], v[124:127], v[196:199]
    ds_read_b64_tr_b16 v[184:185], v15 offset:61440
    v_mfma_f32_16x16x32_bf16 v[200:203], v[168:171], v[128:131], v[200:203]
    ds_read_b64_tr_b16 v[186:187], v15 offset:63488
    s_waitcnt lgkmcnt(4)
    v_mfma_f32_16x16x32_bf16 v[196:199], v[172:175], v[132:135], v[196:199]
    ds_read_b64_tr_b16 v[164:165], v16 offset:0
    v_mfma_f32_16x16x32_bf16 v[200:203], v[172:175], v[136:139], v[200:203]
    ds_read_b64_tr_b16 v[166:167], v16 offset:2048
    v_mfma_f32_16x16x32_bf16 v[196:199], v[176:179], v[140:143], v[196:199]
    ds_read_b64_tr_b16 v[168:169], v16 offset:4096
    v_mfma_f32_16x16x32_bf16 v[200:203], v[176:179], v[144:147], v[200:203]
    ds_read_b64_tr_b16 v[170:171], v16 offset:6144
    s_waitcnt lgkmcnt(4)
    v_mfma_f32_16x16x32_bf16 v[196:199], v[180:183], v[148:151], v[196:199]
    ds_read_b64_tr_b16 v[172:173], v16 offset:8192
    v_mfma_f32_16x16x32_bf16 v[200:203], v[180:183], v[152:155], v[200:203]
    ds_read_b64_tr_b16 v[174:175], v16 offset:10240
    v_mfma_f32_16x16x32_bf16 v[196:199], v[184:187], v[156:159], v[196:199]
    ds_read_b64_tr_b16 v[176:177], v16 offset:12288
    v_mfma_f32_16x16x32_bf16 v[200:203], v[184:187], v[160:163], v[200:203]
    ds_read_b64_tr_b16 v[178:179], v16 offset:14336
    s_waitcnt vmcnt(0)
    v_readfirstlane_b32 s58, v23
    s_mov_b32 s99, 200000
    s_cmp_lg_u32 s58, 0
    s_cbranch_scc0 L_n_3
L_nk_4:
    s_waitcnt lgkmcnt(0)
    s_barrier
    s_setprio 2
    v_mfma_f32_16x16x32_bf16 v[204:207], v[164:167], v[36:39], 0
    ds_read_b64_tr_b16 v[180:181], v16 offset:16384
    v_mfma_f32_16x16x32_bf16 v[208:211], v[164:167], v[40:43], 0
    ds_read_b64_tr_b16 v[182:183], v16 offset:18432
    v_mfma_f32_16x16x32_bf16 v[204:207], v[168:171], v[44:47], v[204:207]
    ds_read_b64_tr_b16 v[184:185], v16 offset:20480
    v_mfma_f32_16x16x32_bf16 v[208:211], v[168:171], v[48:51], v[208:211]
    ds_read_b64_tr_b16 v[186:187], v16 offset:22528
    v_mfma_f32_16x16x32_bf16 v[204:207], v[172:175], v[52:55], v[204:207]
    ds_read_b64_tr_b16 v[164:165], v16 offset:24576
    v_mfma_f32_16x16x32_bf16 v[208:211], v[172:175], v[56:59], v[208:211]
    ds_read_b64_tr_b16 v[166:167], v16 offset:26624
    v_mfma_f32_16x16x32_bf16 v[204:207], v[176:179], v[60:63], v[204:207]
    ds_read_b64_tr_b16 v[168:169], v16 offset:28672
    v_mfma_f32_16x16x32_bf16 v[208:211], v[176:179], v[64:67], v[208:211]
    ds_read_b64_tr_b16 v[170:171], v16 offset:30720
    s_waitcnt lgkmcnt(4)
    v_mfma_f32_16x16x32_bf16 v[204:207], v[180:183], v[68:71], v[204:207]
    ds_read_b64_tr_b16 v[172:173], v16 offset:32768
    v_mfma_f32_16x16x32_bf16 v[208:211], v[180:183], v[72:75], v[208:211]
    ds_read_b64_tr_b16 v[174:175], v16 offset:34816
    v_mfma_f32_16x16x32_bf16 v[204:207], v[184:187], v[76:79], v[204:207]
    ds_read_b64_tr_b16 v[176:177], v16 offset:36864
    v_mfma_f32_16x16x32_bf16 v[208:211], v[184:187], v[80:83], v[208:211]
    ds_read_b64_tr_b16 v[178:179], v16 offset:38912
    s_waitcnt lgkmcnt(4)
    v_mfma_f32_16x16x32_bf16 v[204:207], v[164:167], v[84:87], v[204:207]
    ds_read_b64_tr_b16 v[180:181], v16 offset:40960
    v_mfma_f32_16x16x32_bf16 v[208:211], v[164:167], v[88:91], v[208:211]
    ds_read_b64_tr_b16 v[182:183], v16 offset:43008
    v_mfma_f32_16x16x32_bf16 v[204:207], v[168:171], v[92:95], v[204:207]
    ds_read_b64_tr_b16 v[184:185], v16 offset:45056
    v_mfma_f32_16x16x32_bf16 v[208:211], v[168:171], v[96:99], v[208:211]
    ds_read_b64_tr_b16 v[186:187], v16 offset:47104
    s_waitcnt lgkmcnt(4)
    v_mfma_f32_16x16x32_bf16 v[204:207], v[172:175], v[100:103], v[204:207]
    ds_read_b64_tr_b16 v[164:165], v16 offset:49152
    v_mfma_f32_16x16x32_bf16 v[208:211], v[172:175], v[104:107], v[208:211]
    ds_read_b64_tr_b16 v[166:167], v16 offset:51200
    v_mfma_f32_16x16x32_bf16 v[204:207], v[176:179], v[108:111], v[204:207]
    ds_read_b64_tr_b16 v[168:169], v16 offset:53248
    v_mfma_f32_16x16x32_bf16 v[208:211], v[176:179], v[112:115], v[208:211]
    ds_read_b64_tr_b16 v[170:171], v16 offset:55296
    s_waitcnt lgkmcnt(4)
    v_mfma_f32_16x16x32_bf16 v[204:207], v[180:183], v[116:119], v[204:207]
    ds_read_b64_tr_b16 v[172:173], v16 offset:57344
    v_mfma_f32_16x16x32_bf16 v[208:211], v[180:183], v[120:123], v[208:211]
    ds_read_b64_tr_b16 v[174:175], v16 offset:59392
    v_mfma_f32_16x16x32_bf16 v[204:207], v[184:187], v[124:127], v[204:207]
    ds_read_b64_tr_b16 v[176:177], v16 offset:61440
    v_mfma_f32_16x16x32_bf16 v[208:211], v[184:187], v[128:131], v[208:211]
    ds_read_b64_tr_b16 v[178:179], v16 offset:63488
    s_waitcnt lgkmcnt(4)
    v_mfma_f32_16x16x32_bf16 v[204:207], v[164:167], v[132:135], v[204:207]
    ds_read_b64_tr_b16 v[180:181], v17 offset:0
    v_mfma_f32_16x16x32_bf16 v[208:211], v[164:167], v[136:139], v[208:211]
    ds_read_b64_tr_b16 v[182:183], v17 offset:2048
    v_mfma_f32_16x16x32_bf16 v[204:207], v[168:171], v[140:143], v[204:207]
    ds_read_b64_tr_b16 v[184:185], v17 offset:4096
    v_mfma_f32_16x16x32_bf16 v[208:211], v[168:171], v[144:147], v[208:211]
    ds_read_b64_tr_b16 v[186:187], v17 offset:6144
    s_waitcnt lgkmcnt(4)
    v_mfma_f32_16x16x32_bf16 v[204:207], v[172:175], v[148:151], v[204:207]
    ds_read_b64_tr_b16 v[164:165], v17 offset:8192
    v_mfma_f32_16x16x32_bf16 v[208:211], v[172:175], v[152:155], v[208:211]
    ds_read_b64_tr_b16 v[166:167], v17 offset:10240
    v_mfma_f32_16x16x32_bf16 v[204:207], v[176:179], v[156:159], v[204:207]
    ds_read_b64_tr_b16 v[168:169], v17 offset:12288
    v_mfma_f32_16x16x32_bf16 v[208:211], v[176:179], v[160:163], v[208:211]
    ds_read_b64_tr_b16 v[170:171], v17 offset:14336
    s_waitcnt lgkmcnt(4)
    v_mfma_f32_16x16x32_bf16 v[212:215], v[180:183], v[36:39], 0
    ds_read_b64_tr_b16 v[172:173], v17 offset:16384
    v_mfma_f32_16x16x32_bf16 v[216:219], v[180:183], v[40:43], 0
    ds_read_b64_tr_b16 v[174:175], v17 offset:18432
    v_mfma_f32_16x16x32_bf16 v[212:215], v[184:187], v[44:47], v[212:215]
    ds_read_b64_tr_b16 v[176:177], v17 offset:20480
    v_mfma_f32_16x16x32_bf16 v[216:219], v[184:187], v[48:51], v[216:219]
    ds_read_b64_tr_b16 v[178:179], v17 offset:22528
    s_waitcnt lgkmcnt(4)
    v_mfma_f32_16x16x32_bf16 v[212:215], v[164:167], v[52:55], v[212:215]
    ds_read_b64_tr_b16 v[180:181], v17 offset:24576
    v_mfma_f32_16x16x32_bf16 v[216:219], v[164:167], v[56:59], v[216:219]
    ds_read_b64_tr_b16 v[182:183], v17 offset:26624
    v_mfma_f32_16x16x32_bf16 v[212:215], v[168:171], v[60:63], v[212:215]
    ds_read_b64_tr_b16 v[184:185], v17 offset:28672
    v_mfma_f32_16x16x32_bf16 v[216:219], v[168:171], v[64:67], v[216:219]
    ds_read_b64_tr_b16 v[186:187], v17 offset:30720
    s_waitcnt lgkmcnt(4)
    v_mfma_f32_16x16x32_bf16 v[212:215], v[172:175], v[68:71], v[212:215]
    ds_read_b64_tr_b16 v[164:165], v17 offset:32768
    v_mfma_f32_16x16x32_bf16 v[216:219], v[172:175], v[72:75], v[216:219]
    ds_read_b64_tr_b16 v[166:167], v17 offset:34816
    v_mfma_f32_16x16x32_bf16 v[212:215], v[176:179], v[76:79], v[212:215]
    ds_read_b64_tr_b16 v[168:169], v17 offset:36864
    v_mfma_f32_16x16x32_bf16 v[216:219], v[176:179], v[80:83], v[216:219]
    ds_read_b64_tr_b16 v[170:171], v17 offset:38912
    s_waitcnt lgkmcnt(4)
    v_mfma_f32_16x16x32_bf16 v[212:215], v[180:183], v[84:87], v[212:215]
    ds_read_b64_tr_b16 v[172:173], v17 offset:40960
    v_mfma_f32_16x16x32_bf16 v[216:219], v[180:183], v[88:91], v[216:219]
    ds_read_b64_tr_b16 v[174:175], v17 offset:43008
    v_mfma_f32_16x16x32_bf16 v[212:215], v[184:187], v[92:95], v[212:215]
    ds_read_b64_tr_b16 v[176:177], v17 offset:45056
    v_mfma_f32_16x16x32_bf16 v[216:219], v[184:187], v[96:99], v[216:219]
    ds_read_b64_tr_b16 v[178:179], v17 offset:47104
    s_waitcnt lgkmcnt(4)
    v_mfma_f32_16x16x32_bf16 v[212:215], v[164:167], v[100:103], v[212:215]
    ds_read_b64_tr_b16 v[180:181], v17 offset:49152
    v_mfma_f32_16x16x32_bf16 v[216:219], v[164:167], v[104:107], v[216:219]
    ds_read_b64_tr_b16 v[182:183], v17 offset:51200
    v_mfma_f32_16x16x32_bf16 v[212:215], v[168:171], v[108:111], v[212:215]
    ds_read_b64_tr_b16 v[184:185], v17 offset:53248
    v_mfma_f32_16x16x32_bf16 v[216:219], v[168:171], v[112:115], v[216:219]
    ds_read_b64_tr_b16 v[186:187], v17 offset:55296
    s_waitcnt lgkmcnt(4)
    v_mfma_f32_16x16x32_bf16 v[212:215], v[172:175], v[116:119], v[212:215]
    ds_read_b64_tr_b16 v[164:165], v17 offset:57344
    v_mfma_f32_16x16x32_bf16 v[216:219], v[172:175], v[120:123], v[216:219]
    ds_read_b64_tr_b16 v[166:167], v17 offset:59392
    v_mfma_f32_16x16x32_bf16 v[212:215], v[176:179], v[124:127], v[212:215]
    ds_read_b64_tr_b16 v[168:169], v17 offset:61440
    v_mfma_f32_16x16x32_bf16 v[216:219], v[176:179], v[128:131], v[216:219]
    ds_read_b64_tr_b16 v[170:171], v17 offset:63488
    s_waitcnt lgkmcnt(4)
    v_mfma_f32_16x16x32_bf16 v[212:215], v[180:183], v[132:135], v[212:215]
    ds_read_b64_tr_b16 v[172:173], v19 offset:32768
    v_mfma_f32_16x16x32_bf16 v[216:219], v[180:183], v[136:139], v[216:219]
    ds_read_b64_tr_b16 v[174:175], v19 offset:34304
    v_mfma_f32_16x16x32_bf16 v[212:215], v[184:187], v[140:143], v[212:215]
    ds_read_b64_tr_b16 v[176:177], v19 offset:35840
    v_mfma_f32_16x16x32_bf16 v[216:219], v[184:187], v[144:147], v[216:219]
    ds_read_b64_tr_b16 v[178:179], v19 offset:37376
    s_waitcnt lgkmcnt(4)
    v_mfma_f32_16x16x32_bf16 v[212:215], v[164:167], v[148:151], v[212:215]
    ds_read_b64_tr_b16 v[180:181], v19 offset:38912
    v_mfma_f32_16x16x32_bf16 v[216:219], v[164:167], v[152:155], v[216:219]
    ds_read_b64_tr_b16 v[182:183], v19 offset:40448
    v_mfma_f32_16x16x32_bf16 v[212:215], v[168:171], v[156:159], v[212:215]
    ds_read_b64_tr_b16 v[184:185], v19 offset:41984
    v_mfma_f32_16x16x32_bf16 v[216:219], v[168:171], v[160:163], v[216:219]
    ds_read_b64_tr_b16 v[186:187], v19 offset:43520
    s_mov_b64 exec, 1
    ds_add_u32 v12, v13 offset:4
    s_mov_b64 exec, -1
    s_waitcnt lgkmcnt(5)
    v_mfma_f32_16x16x32_bf16 v[220:223], v[172:175], v[36:39], 0
    ds_read_b64_tr_b16 v[164:165], v20 offset:24576
    v_mfma_f32_16x16x32_bf16 v[224:227], v[172:175], v[40:43], 0
    ds_read_b64_tr_b16 v[166:167], v20 offset:26112
    v_mfma_f32_16x16x32_bf16 v[220:223], v[176:179], v[44:47], v[220:223]
    ds_read_b64_tr_b16 v[168:169], v20 offset:27648
    v_mfma_f32_16x16x32_bf16 v[224:227], v[176:179], v[48:51], v[224:227]
    ds_read_b64_tr_b16 v[170:171], v20 offset:29184
    s_waitcnt lgkmcnt(5)
    v_mfma_f32_16x16x32_bf16 v[220:223], v[180:183], v[52:55], v[220:223]
    ds_read_b64_tr_b16 v[172:173], v20 offset:30720
    v_mfma_f32_16x16x32_bf16 v[224:227], v[180:183], v[56:59], v[224:227]
    ds_read_b64_tr_b16 v[174:175], v20 offset:32256
    v_mfma_f32_16x16x32_bf16 v[220:223], v[184:187], v[60:63], v[220:223]
    ds_read_b64_tr_b16 v[176:177], v20 offset:33792
    v_mfma_f32_16x16x32_bf16 v[224:227], v[184:187], v[64:67], v[224:227]
    ds_read_b64_tr_b16 v[178:179], v20 offset:35328
    s_waitcnt lgkmcnt(4)
    v_mfma_f32_16x16x32_bf16 v[220:223], v[164:167], v[68:71], v[220:223]
    ds_read_b64_tr_b16 v[180:181], v19 offset:0
    v_mfma_f32_16x16x32_bf16 v[224:227], v[164:167], v[72:75], v[224:227]
    ds_read_b64_tr_b16 v[182:183], v19 offset:1536
    v_mfma_f32_16x16x32_bf16 v[220:223], v[168:171], v[76:79], v[220:223]
    ds_read_b64_tr_b16 v[184:185], v19 offset:3072
    v_mfma_f32_16x16x32_bf16 v[224:227], v[168:171], v[80:83], v[224:227]
    ds_read_b64_tr_b16 v[186:187], v19 offset:4608
    s_waitcnt lgkmcnt(4)
    v_mfma_f32_16x16x32_bf16 v[220:223], v[172:175], v[84:87], v[220:223]
    ds_read_b64_tr_b16 v[164:165], v19 offset:6144
    v_mfma_f32_16x16x32_bf16 v[224:227], v[172:175], v[88:91], v[224:227]
    ds_read_b64_tr_b16 v[166:167], v19 offset:7680
    v_mfma_f32_16x16x32_bf16 v[220:223], v[176:179], v[92:95], v[220:223]
    ds_read_b64_tr_b16 v[168:169], v19 offset:9216
    v_mfma_f32_16x16x32_bf16 v[224:227], v[176:179], v[96:99], v[224:227]
    ds_read_b64_tr_b16 v[170:171], v19 offset:10752
    s_waitcnt lgkmcnt(4)
    v_mfma_f32_16x16x32_bf16 v[220:223], v[180:183], v[100:103], v[220:223]
    ds_read_b64_tr_b16 v[172:173], v20 offset:0
    v_mfma_f32_16x16x32_bf16 v[224:227], v[180:183], v[104:107], v[224:227]
    ds_read_b64_tr_b16 v[174:175], v20 offset:1536
    v_mfma_f32_16x16x32_bf16 v[220:223], v[184:187], v[108:111], v[220:223]
    ds_read_b64_tr_b16 v[176:177], v20 offset:3072
    v_mfma_f32_16x16x32_bf16 v[224:227], v[184:187], v[112:115], v[224:227]
    ds_read_b64_tr_b16 v[178:179], v20 offset:4608
    s_waitcnt lgkmcnt(4)
    v_mfma_f32_16x16x32_bf16 v[220:223], v[164:167], v[116:119], v[220:223]
    ds_read_b64_tr_b16 v[180:181], v20 offset:6144
    v_mfma_f32_16x16x32_bf16 v[224:227], v[164:167], v[120:123], v[224:227]
    ds_read_b64_tr_b16 v[182:183], v20 offset:7680
    v_mfma_f32_16x16x32_bf16 v[220:223], v[168:171], v[124:127], v[220:223]
    ds_read_b64_tr_b16 v[184:185], v20 offset:9216
    v_mfma_f32_16x16x32_bf16 v[224:227], v[168:171], v[128:131], v[224:227]
    ds_read_b64_tr_b16 v[186:187], v20 offset:10752
    s_waitcnt lgkmcnt(4)
    v_mfma_f32_16x16x32_bf16 v[220:223], v[172:175], v[132:135], v[220:223]
    ds_read_b64_tr_b16 v[164:165], v19 offset:32800
    v_mfma_f32_16x16x32_bf16 v[224:227], v[172:175], v[136:139], v[224:227]
    ds_read_b64_tr_b16 v[166:167], v19 offset:34336
    v_mfma_f32_16x16x32_bf16 v[220:223], v[176:179], v[140:143], v[220:223]
    ds_read_b64_tr_b16 v[168:169], v19 offset:35872
    v_mfma_f32_16x16x32_bf16 v[224:227], v[176:179], v[144:147], v[224:227]
    ds_read_b64_tr_b16 v[170:171], v19 offset:37408
    s_waitcnt lgkmcnt(4)
    v_mfma_f32_16x16x32_bf16 v[220:223], v[180:183], v[148:151], v[220:223]
    ds_read_b64_tr_b16 v[172:173], v19 offset:38944
    v_mfma_f32_16x16x32_bf16 v[224:227], v[180:183], v[152:155], v[224:227]
    ds_read_b64_tr_b16 v[174:175], v19 offset:40480
    v_mfma_f32_16x16x32_bf16 v[220:223], v[184:187], v[156:159], v[220:223]
    ds_read_b64_tr_b16 v[176:177], v19 offset:42016
    v_mfma_f32_16x16x32_bf16 v[224:227], v[184:187], v[160:163], v[224:227]
    ds_read_b64_tr_b16 v[178:179], v19 offset:43552
    s_waitcnt lgkmcnt(4)
    v_mfma_f32_16x16x32_bf16 v[228:231], v[164:167], v[36:39], 0
    ds_read_b64_tr_b16 v[180:181], v20 offset:24608
    v_mfma_f32_16x16x32_bf16 v[232:235], v[164:167], v[40:43], 0
    ds_read_b64_tr_b16 v[182:183], v20 offset:26144
    v_mfma_f32_16x16x32_bf16 v[228:231], v[168:171], v[44:47], v[228:231]
    ds_read_b64_tr_b16 v[184:185], v20 offset:27680
    v_mfma_f32_16x16x32_bf16 v[232:235], v[168:171], v[48:51], v[232:235]
    ds_read_b64_tr_b16 v[186:187], v20 offset:29216
    s_waitcnt lgkmcnt(4)
    v_mfma_f32_16x16x32_bf16 v[228:231], v[172:175], v[52:55], v[228:231]
    ds_read_b64_tr_b16 v[164:165], v20 offset:30752
    v_mfma_f32_16x16x32_bf16 v[232:235], v[172:175], v[56:59], v[232:235]
    ds_read_b64_tr_b16 v[166:167], v20 offset:32288
    v_mfma_f32_16x16x32_bf16 v[228:231], v[176:179], v[60:63], v[228:231]
    ds_read_b64_tr_b16 v[168:169], v20 offset:33824
    v_mfma_f32_16x16x32_bf16 v[232:235], v[176:179], v[64:67], v[232:235]
    ds_read_b64_tr_b16 v[170:171], v20 offset:35360
    s_waitcnt lgkmcnt(4)
    v_mfma_f32_16x16x32_bf16 v[228:231], v[180:183], v[68:71], v[228:231]
    ds_read_b64_tr_b16 v[172:173], v19 offset:32
    v_mfma_f32_16x16x32_bf16 v[232:235], v[180:183], v[72:75], v[232:235]
    ds_read_b64_tr_b16 v[174:175], v19 offset:1568
    v_mfma_f32_16x16x32_bf16 v[228:231], v[184:187], v[76:79], v[228:231]
    ds_read_b64_tr_b16 v[176:177], v19 offset:3104
    v_mfma_f32_16x16x32_bf16 v[232:235], v[184:187], v[80:83], v[232:235]
    ds_read_b64_tr_b16 v[178:179], v19 offset:4640
    s_waitcnt lgkmcnt(4)
    v_mfma_f32_16x16x32_bf16 v[228:231], v[164:167], v[84:87], v[228:231]
    ds_read_b64_tr_b16 v[180:181], v19 offset:6176
    v_mfma_f32_16x16x32_bf16 v[232:235], v[164:167], v[88:91], v[232:235]
    ds_read_b64_tr_b16 v[182:183], v19 offset:7712
    v_mfma_f32_16x16x32_bf16 v[228:231], v[168:171], v[92:95], v[228:231]
    ds_read_b64_tr_b16 v[184:185], v19 offset:9248
    v_mfma_f32_16x16x32_bf16 v[232:235], v[168:171], v[96:99], v[232:235]
    ds_read_b64_tr_b16 v[186:187], v19 offset:10784
    s_waitcnt lgkmcnt(4)
    v_mfma_f32_16x16x32_bf16 v[228:231], v[172:175], v[100:103], v[228:231]
    ds_read_b64_tr_b16 v[164:165], v20 offset:32
    v_mfma_f32_16x16x32_bf16 v[232:235], v[172:175], v[104:107], v[232:235]
    ds_read_b64_tr_b16 v[166:167], v20 offset:1568
    v_mfma_f32_16x16x32_bf16 v[228:231], v[176:179], v[108:111], v[228:231]
    ds_read_b64_tr_b16 v[168:169], v20 offset:3104
    v_mfma_f32_16x16x32_bf16 v[232:235], v[176:179], v[112:115], v[232:235]
    ds_read_b64_tr_b16 v[170:171], v20 offset:4640
    s_waitcnt lgkmcnt(4)
    v_mfma_f32_16x16x32_bf16 v[228:231], v[180:183], v[116:119], v[228:231]
    ds_read_b64_tr_b16 v[172:173], v20 offset:6176
    v_mfma_f32_16x16x32_bf16 v[232:235], v[180:183], v[120:123], v[232:235]
    ds_read_b64_tr_b16 v[174:175], v20 offset:7712
    v_mfma_f32_16x16x32_bf16 v[228:231], v[184:187], v[124:127], v[228:231]
    ds_read_b64_tr_b16 v[176:177], v20 offset:9248
    v_mfma_f32_16x16x32_bf16 v[232:235], v[184:187], v[128:131], v[232:235]
    ds_read_b64_tr_b16 v[178:179], v20 offset:10784
    s_waitcnt lgkmcnt(4)
    v_mfma_f32_16x16x32_bf16 v[228:231], v[164:167], v[132:135], v[228:231]
    ds_read_b64_tr_b16 v[180:181], v19 offset:32832
    v_mfma_f32_16x16x32_bf16 v[232:235], v[164:167], v[136:139], v[232:235]
    ds_read_b64_tr_b16 v[182:183], v19 offset:34368
    v_mfma_f32_16x16x32_bf16 v[228:231], v[168:171], v[140:143], v[228:231]
    ds_read_b64_tr_b16 v[184:185], v19 offset:35904
    v_mfma_f32_16x16x32_bf16 v[232:235], v[168:171], v[144:147], v[232:235]
    ds_read_b64_tr_b16 v[186:187], v19 offset:37440
    s_waitcnt lgkmcnt(4)
    v_mfma_f32_16x16x32_bf16 v[228:231], v[172:175], v[148:151], v[228:231]
    ds_read_b64_tr_b16 v[164:165], v19 offset:38976
    v_mfma_f32_16x16x32_bf16 v[232:235], v[172:175], v[152:155], v[232:235]
    ds_read_b64_tr_b16 v[166:167], v19 offset:40512
    v_mfma_f32_16x16x32_bf16 v[228:231], v[176:179], v[156:159], v[228:231]
    ds_read_b64_tr_b16 v[168:169], v19 offset:42048
    v_mfma_f32_16x16x32_bf16 v[232:235], v[176:179], v[160:163], v[232:235]
    ds_read_b64_tr_b16 v[170:171], v19 offset:43584
    ds_read_b32 v4, v12 offset:0
    s_waitcnt lgkmcnt(5)
    v_mfma_f32_16x16x32_bf16 v[236:239], v[180:183], v[36:39], 0
    ds_read_b64_tr_b16 v[172:173], v20 offset:24640
    v_mfma_f32_16x16x32_bf16 v[240:243], v[180:183], v[40:43], 0
    ds_read_b64_tr_b16 v[174:175], v20 offset:26176
    v_mfma_f32_16x16x32_bf16 v[236:239], v[184:187], v[44:47], v[236:239]
    ds_read_b64_tr_b16 v[176:177], v20 offset:27712
    v_mfma_f32_16x16x32_bf16 v[240:243], v[184:187], v[48:51], v[240:243]
    ds_read_b64_tr_b16 v[178:179], v20 offset:29248
    s_waitcnt lgkmcnt(5)
    v_mfma_f32_16x16x32_bf16 v[236:239], v[164:167], v[52:55], v[236:239]
    ds_read_b64_tr_b16 v[180:181], v20 offset:30784
    v_mfma_f32_16x16x32_bf16 v[240:243], v[164:167], v[56:59], v[240:243]
    ds_read_b64_tr_b16 v[182:183], v20 offset:32320
    v_mfma_f32_16x16x32_bf16 v[236:239], v[168:171], v[60:63], v[236:239]
    ds_read_b64_tr_b16 v[184:185], v20 offset:33856
    v_mfma_f32_16x16x32_bf16 v[240:243], v[168:171], v[64:67], v[240:243]
    ds_read_b64_tr_b16 v[186:187], v20 offset:35392
    s_waitcnt lgkmcnt(4)
    v_mfma_f32_16x16x32_bf16 v[236:239], v[172:175], v[68:71], v[236:239]
    ds_read_b64_tr_b16 v[164:165], v19 offset:64
    v_mfma_f32_16x16x32_bf16 v[240:243], v[172:175], v[72:75], v[240:243]
    ds_read_b64_tr_b16 v[166:167], v19 offset:1600
    v_mfma_f32_16x16x32_bf16 v[236:239], v[176:179], v[76:79], v[236:239]
    ds_read_b64_tr_b16 v[168:169], v19 offset:3136
    v_mfma_f32_16x16x32_bf16 v[240:243], v[176:179], v[80:83], v[240:243]
    ds_read_b64_tr_b16 v[170:171], v19 offset:4672
    s_waitcnt lgkmcnt(4)
    v_mfma_f32_16x16x32_bf16 v[236:239], v[180:183], v[84:87], v[236:239]
    ds_read_b64_tr_b16 v[172:173], v19 offset:6208
    v_mfma_f32_16x16x32_bf16 v[240:243], v[180:183], v[88:91], v[240:243]
    ds_read_b64_tr_b16 v[174:175], v19 offset:7744
    v_mfma_f32_16x16x32_bf16 v[236:239], v[184:187], v[92:95], v[236:239]
    ds_read_b64_tr_b16 v[176:177], v19 offset:9280
    v_mfma_f32_16x16x32_bf16 v[240:243], v[184:187], v[96:99], v[240:243]
    ds_read_b64_tr_b16 v[178:179], v19 offset:10816
    s_waitcnt lgkmcnt(4)
    v_mfma_f32_16x16x32_bf16 v[236:239], v[164:167], v[100:103], v[236:239]
    ds_read_b64_tr_b16 v[180:181], v20 offset:64
    v_mfma_f32_16x16x32_bf16 v[240:243], v[164:167], v[104:107], v[240:243]
    ds_read_b64_tr_b16 v[182:183], v20 offset:1600
    v_mfma_f32_16x16x32_bf16 v[236:239], v[168:171], v[108:111], v[236:239]
    ds_read_b64_tr_b16 v[184:185], v20 offset:3136
    v_mfma_f32_16x16x32_bf16 v[240:243], v[168:171], v[112:115], v[240:243]
    ds_read_b64_tr_b16 v[186:187], v20 offset:4672
    s_waitcnt lgkmcnt(4)
    v_mfma_f32_16x16x32_bf16 v[236:239], v[172:175], v[116:119], v[236:239]
    ds_read_b64_tr_b16 v[164:165], v20 offset:6208
    v_mfma_f32_16x16x32_bf16 v[240:243], v[172:175], v[120:123], v[240:243]
    ds_read_b64_tr_b16 v[166:167], v20 offset:7744
    v_mfma_f32_16x16x32_bf16 v[236:239], v[176:179], v[124:127], v[236:239]
    ds_read_b64_tr_b16 v[168:169], v20 offset:9280
    v_mfma_f32_16x16x32_bf16 v[240:243], v[176:179], v[128:131], v[240:243]
    ds_read_b64_tr_b16 v[170:171], v20 offset:10816
    s_waitcnt lgkmcnt(4)
    v_mfma_f32_16x16x32_bf16 v[236:239], v[180:183], v[132:135], v[236:239]
    v_mfma_f32_16x16x32_bf16 v[240:243], v[180:183], v[136:139], v[240:243]
    v_mfma_f32_16x16x32_bf16 v[236:239], v[184:187], v[140:143], v[236:239]
    v_mfma_f32_16x16x32_bf16 v[240:243], v[184:187], v[144:147], v[240:243]
    s_waitcnt lgkmcnt(0)
    v_mfma_f32_16x16x32_bf16 v[236:239], v[164:167], v[148:151], v[236:239]
    v_mfma_f32_16x16x32_bf16 v[240:243], v[164:167], v[152:155], v[240:243]
    v_mfma_f32_16x16x32_bf16 v[236:239], v[168:171], v[156:159], v[236:239]
    v_mfma_f32_16x16x32_bf16 v[240:243], v[168:171], v[160:163], v[240:243]
    s_mov_b64 exec, 1
    ds_add_u32 v12, v13 offset:8
    s_mov_b64 exec, -1
    s_waitcnt lgkmcnt(0)
    v_readfirstlane_b32 s59, v4
    s_mov_b32 s99, 1600000
    s_cmp_lt_u32 s59, 4
    s_cbranch_scc1 L_lw_5
L_lo_6:
    ds_read_b128 v[108:111], v22
    ds_read_b128 v[112:115], v22 offset:256
    ds_read_b64 v[92:93], v24
    ds_read_b128 v[128:131], v21 offset:0
    ds_read_b64 v[94:95], v25
    ds_read_b128 v[132:135], v21 offset:64
    ds_read_b64 v[96:97], v26
    ds_read_b128 v[136:139], v21 offset:128
    ds_read_b64 v[98:99], v27
    ds_read_b128 v[140:143], v21 offset:192
    ds_read_b64 v[100:101], v28
    ds_read_b128 v[144:147], v21 offset:256
    ds_read_b64 v[102:103], v29
    ds_read_b128 v[148:151], v21 offset:320
    ds_read_b64 v[104:105], v30
    ds_read_b128 v[152:155], v21 offset:384
    s_waitcnt lgkmcnt(10)
    v_lshlrev_b32 v68, 16, v92
    v_and_b32 v69, 0xffff0000, v92
    v_lshlrev_b32 v70, 16, v93
    v_and_b32 v71, 0xffff0000, v93
    v_lshlrev_b32 v72, 16, v94
    v_and_b32 v73, 0xffff0000, v94
    v_lshlrev_b32 v74, 16, v95
    v_and_b32 v75, 0xffff0000, v95
    v_pk_fma_f32 v[36:37], v[128:129], v[108:109], v[68:69] op_sel:[0,1,0] op_sel_hi:[1,1,1]
    v_pk_fma_f32 v[38:39], v[130:131], v[108:109], v[70:71] op_sel:[0,1,0] op_sel_hi:[1,1,1]
    v_pk_fma_f32 v[40:41], v[128:129], v[112:113], v[68:69] op_sel:[0,1,0] op_sel_hi:[1,1,1]
    v_pk_fma_f32 v[42:43], v[130:131], v[112:113], v[70:71] op_sel:[0,1,0] op_sel_hi:[1,1,1]
    v_pk_fma_f32 v[44:45], v[132:133], v[108:109], v[72:73] op_sel:[0,1,0] op_sel_hi:[1,1,1]
    v_pk_fma_f32 v[46:47], v[134:135], v[108:109], v[74:75] op_sel:[0,1,0] op_sel_hi:[1,1,1]
    v_pk_fma_f32 v[48:49], v[132:133], v[112:113], v[72:73] op_sel:[0,1,0] op_sel_hi:[1,1,1]
    v_pk_fma_f32 v[50:51], v[134:135], v[112:113], v[74:75] op_sel:[0,1,0] op_sel_hi:[1,1,1]
    v_pk_fma_f32 v[188:189], v[188:189], v[108:109], v[36:37] op_sel_hi:[1,0,1]
    v_pk_fma_f32 v[190:191], v[190:191], v[108:109], v[38:39] op_sel_hi:[1,0,1]
    v_pk_fma_f32 v[192:193], v[192:193], v[112:113], v[40:41] op_sel_hi:[1,0,1]
    v_pk_fma_f32 v[194:195], v[194:195], v[112:113], v[42:43] op_sel_hi:[1,0,1]
    v_pk_fma_f32 v[196:197], v[196:197], v[108:109], v[44:45] op_sel_hi:[1,0,1]
    v_pk_fma_f32 v[198:199], v[198:199], v[108:109], v[46:47] op_sel_hi:[1,0,1]
    v_pk_fma_f32 v[200:201], v[200:201], v[112:113], v[48:49] op_sel_hi:[1,0,1]
    v_pk_fma_f32 v[202:203], v[202:203], v[112:113], v[50:51] op_sel_hi:[1,0,1]
    v_pk_mul_f32 v[36:37], v[188:189], v[188:189]
    v_pk_mul_f32 v[38:39], v[190:191], v[190:191]
    v_pk_mul_f32 v[40:41], v[192:193], v[192:193]
    v_pk_mul_f32 v[42:43], v[194:195], v[194:195]
    v_pk_mul_f32 v[44:45], v[196:197], v[196:197]
    v_pk_mul_f32 v[46:47], v[198:199], v[198:199]
    v_pk_mul_f32 v[48:49], v[200:201], v[200:201]
    v_pk_mul_f32 v[50:51], v[202:203], v[202:203]
    v_pk_fma_f32 v[36:37], v[36:37], v[32:33], v[32:33] op_sel:[0,1,0] op_sel_hi:[1,1,0]
    v_pk_fma_f32 v[38:39], v[38:39], v[32:33], v[32:33] op_sel:[0,1,0] op_sel_hi:[1,1,0]
    v_pk_fma_f32 v[40:41], v[40:41], v[32:33], v[32:33] op_sel:[0,1,0] op_sel_hi:[1,1,0]
    v_pk_fma_f32 v[42:43], v[42:43], v[32:33], v[32:33] op_sel:[0,1,0] op_sel_hi:[1,1,0]
    v_pk_fma_f32 v[44:45], v[44:45], v[32:33], v[32:33] op_sel:[0,1,0] op_sel_hi:[1,1,0]
    v_pk_fma_f32 v[46:47], v[46:47], v[32:33], v[32:33] op_sel:[0,1,0] op_sel_hi:[1,1,0]
    v_pk_fma_f32 v[48:49], v[48:49], v[32:33], v[32:33] op_sel:[0,1,0] op_sel_hi:[1,1,0]
    v_pk_fma_f32 v[50:51], v[50:51], v[32:33], v[32:33] op_sel:[0,1,0] op_sel_hi:[1,1,0]
    v_pk_mul_f32 v[36:37], v[36:37], v[188:189]
    v_pk_mul_f32 v[38:39], v[38:39], v[190:191]
    v_pk_mul_f32 v[40:41], v[40:41], v[192:193]
    v_pk_mul_f32 v[42:43], v[42:43], v[194:195]
    v_pk_mul_f32 v[44:45], v[44:45], v[196:197]
    v_pk_mul_f32 v[46:47], v[46:47], v[198:199]
    v_pk_mul_f32 v[48:49], v[48:49], v[200:201]
    v_pk_mul_f32 v[50:51], v[50:51], v[202:203]
    v_exp_f32 v36, v36
    v_exp_f32 v37, v37
    v_exp_f32 v38, v38
    v_exp_f32 v39, v39
    v_exp_f32 v40, v40
    v_exp_f32 v41, v41
    v_exp_f32 v42, v42
    v_exp_f32 v43, v43
    v_exp_f32 v44, v44
    v_exp_f32 v45, v45
    v_exp_f32 v46, v46
    v_exp_f32 v47, v47
    v_exp_f32 v48, v48
    v_exp_f32 v49, v49
    v_exp_f32 v50, v50
    v_exp_f32 v51, v51
    v_pk_fma_f32 v[36:37], v[36:37], v[110:111], v[110:111] op_sel_hi:[1,0,0]
    v_pk_fma_f32 v[38:39], v[38:39], v[110:111], v[110:111] op_sel_hi:[1,0,0]
    v_pk_fma_f32 v[40:41], v[40:41], v[114:115], v[114:115] op_sel_hi:[1,0,0]
    v_pk_fma_f32 v[42:43], v[42:43], v[114:115], v[114:115] op_sel_hi:[1,0,0]
    v_pk_fma_f32 v[44:45], v[44:45], v[110:111], v[110:111] op_sel_hi:[1,0,0]
    v_pk_fma_f32 v[46:47], v[46:47], v[110:111], v[110:111] op_sel_hi:[1,0,0]
    v_pk_fma_f32 v[48:49], v[48:49], v[114:115], v[114:115] op_sel_hi:[1,0,0]
    v_pk_fma_f32 v[50:51], v[50:51], v[114:115], v[114:115] op_sel_hi:[1,0,0]
    v_rcp_f32 v36, v36
    v_rcp_f32 v37, v37
    v_rcp_f32 v38, v38
    v_rcp_f32 v39, v39
    v_rcp_f32 v40, v40
    v_rcp_f32 v41, v41
    v_rcp_f32 v42, v42
    v_rcp_f32 v43, v43
    v_rcp_f32 v44, v44
    v_rcp_f32 v45, v45
    v_rcp_f32 v46, v46
    v_rcp_f32 v47, v47
    v_rcp_f32 v48, v48
    v_rcp_f32 v49, v49
    v_rcp_f32 v50, v50
    v_rcp_f32 v51, v51
    v_pk_mul_f32 v[188:189], v[188:189], v[36:37]
    v_pk_mul_f32 v[190:191], v[190:191], v[38:39]
    v_pk_mul_f32 v[192:193], v[192:193], v[40:41]
    v_pk_mul_f32 v[194:195], v[194:195], v[42:43]
    v_pk_mul_f32 v[196:197], v[196:197], v[44:45]
    v_pk_mul_f32 v[198:199], v[198:199], v[46:47]
    v_pk_mul_f32 v[200:201], v[200:201], v[48:49]
    v_pk_mul_f32 v[202:203], v[202:203], v[50:51]
    v_cvt_pk_bf16_f32 v128, v188, v189
    v_cvt_pk_bf16_f32 v129, v190, v191
    v_cvt_pk_bf16_f32 v130, v192, v193
    v_cvt_pk_bf16_f32 v131, v194, v195
    v_cvt_pk_bf16_f32 v132, v196, v197
    v_cvt_pk_bf16_f32 v133, v198, v199
    v_cvt_pk_bf16_f32 v134, v200, v201
    v_cvt_pk_bf16_f32 v135, v202, v203
    v_permlane16_swap_b32 v128, v130
    v_permlane16_swap_b32 v129, v131
    v_permlane16_swap_b32 v132, v134
    v_permlane16_swap_b32 v133, v135
    buffer_store_dwordx4 v[128:131], v2, s[36:39], s64 offen sc1
    buffer_store_dwordx4 v[132:135], v2, s[36:39], s65 offen sc1
    s_waitcnt lgkmcnt(6)
    v_lshlrev_b32 v68, 16, v96
    v_and_b32 v69, 0xffff0000, v96
    v_lshlrev_b32 v70, 16, v97
    v_and_b32 v71, 0xffff0000, v97
    v_lshlrev_b32 v72, 16, v98
    v_and_b32 v73, 0xffff0000, v98
    v_lshlrev_b32 v74, 16, v99
    v_and_b32 v75, 0xffff0000, v99
    v_pk_fma_f32 v[36:37], v[136:137], v[108:109], v[68:69] op_sel:[0,1,0] op_sel_hi:[1,1,1]
    v_pk_fma_f32 v[38:39], v[138:139], v[108:109], v[70:71] op_sel:[0,1,0] op_sel_hi:[1,1,1]
    v_pk_fma_f32 v[40:41], v[136:137], v[112:113], v[68:69] op_sel:[0,1,0] op_sel_hi:[1,1,1]
    v_pk_fma_f32 v[42:43], v[138:139], v[112:113], v[70:71] op_sel:[0,1,0] op_sel_hi:[1,1,1]
    v_pk_fma_f32 v[44:45], v[140:141], v[108:109], v[72:73] op_sel:[0,1,0] op_sel_hi:[1,1,1]
    v_pk_fma_f32 v[46:47], v[142:143], v[108:109], v[74:75] op_sel:[0,1,0] op_sel_hi:[1,1,1]
    v_pk_fma_f32 v[48:49], v[140:141], v[112:113], v[72:73] op_sel:[0,1,0] op_sel_hi:[1,1,1]
    v_pk_fma_f32 v[50:51], v[142:143], v[112:113], v[74:75] op_sel:[0,1,0] op_sel_hi:[1,1,1]
    v_pk_fma_f32 v[204:205], v[204:205], v[108:109], v[36:37] op_sel_hi:[1,0,1]
    v_pk_fma_f32 v[206:207], v[206:207], v[108:109], v[38:39] op_sel_hi:[1,0,1]
    v_pk_fma_f32 v[208:209], v[208:209], v[112:113], v[40:41] op_sel_hi:[1,0,1]
    v_pk_fma_f32 v[210:211], v[210:211], v[112:113], v[42:43] op_sel_hi:[1,0,1]
    v_pk_fma_f32 v[212:213], v[212:213], v[108:109], v[44:45] op_sel_hi:[1,0,1]
    v_pk_fma_f32 v[214:215], v[214:215], v[108:109], v[46:47] op_sel_hi:[1,0,1]
    v_pk_fma_f32 v[216:217], v[216:217], v[112:113], v[48:49] op_sel_hi:[1,0,1]
    v_pk_fma_f32 v[218:219], v[218:219], v[112:113], v[50:51] op_sel_hi:[1,0,1]
    v_pk_mul_f32 v[36:37], v[204:205], v[204:205]
    v_pk_mul_f32 v[38:39], v[206:207], v[206:207]
    v_pk_mul_f32 v[40:41], v[208:209], v[208:209]
    v_pk_mul_f32 v[42:43], v[210:211], v[210:211]
    v_pk_mul_f32 v[44:45], v[212:213], v[212:213]
    v_pk_mul_f32 v[46:47], v[214:215], v[214:215]
    v_pk_mul_f32 v[48:49], v[216:217], v[216:217]
    v_pk_mul_f32 v[50:51], v[218:219], v[218:219]
    v_pk_fma_f32 v[36:37], v[36:37], v[32:33], v[32:33] op_sel:[0,1,0] op_sel_hi:[1,1,0]
    v_pk_fma_f32 v[38:39], v[38:39], v[32:33], v[32:33] op_sel:[0,1,0] op_sel_hi:[1,1,0]
    v_pk_fma_f32 v[40:41], v[40:41], v[32:33], v[32:33] op_sel:[0,1,0] op_sel_hi:[1,1,0]
    v_pk_fma_f32 v[42:43], v[42:43], v[32:33], v[32:33] op_sel:[0,1,0] op_sel_hi:[1,1,0]
    v_pk_fma_f32 v[44:45], v[44:45], v[32:33], v[32:33] op_sel:[0,1,0] op_sel_hi:[1,1,0]
    v_pk_fma_f32 v[46:47], v[46:47], v[32:33], v[32:33] op_sel:[0,1,0] op_sel_hi:[1,1,0]
    v_pk_fma_f32 v[48:49], v[48:49], v[32:33], v[32:33] op_sel:[0,1,0] op_sel_hi:[1,1,0]
    v_pk_fma_f32 v[50:51], v[50:51], v[32:33], v[32:33] op_sel:[0,1,0] op_sel_hi:[1,1,0]
    v_pk_mul_f32 v[36:37], v[36:37], v[204:205]
    v_pk_mul_f32 v[38:39], v[38:39], v[206:207]
    v_pk_mul_f32 v[40:41], v[40:41], v[208:209]
    v_pk_mul_f32 v[42:43], v[42:43], v[210:211]
    v_pk_mul_f32 v[44:45], v[44:45], v[212:213]
    v_pk_mul_f32 v[46:47], v[46:47], v[214:215]
    v_pk_mul_f32 v[48:49], v[48:49], v[216:217]
    v_pk_mul_f32 v[50:51], v[50:51], v[218:219]
    v_exp_f32 v36, v36
    v_exp_f32 v37, v37
    v_exp_f32 v38, v38
    v_exp_f32 v39, v39
    v_exp_f32 v40, v40
    v_exp_f32 v41, v41
    v_exp_f32 v42, v42
    v_exp_f32 v43, v43
    v_exp_f32 v44, v44
    v_exp_f32 v45, v45
    v_exp_f32 v46, v46
    v_exp_f32 v47, v47
    v_exp_f32 v48, v48
    v_exp_f32 v49, v49
    v_exp_f32 v50, v50
    v_exp_f32 v51, v51
    v_pk_fma_f32 v[36:37], v[36:37], v[110:111], v[110:111] op_sel_hi:[1,0,0]
    v_pk_fma_f32 v[38:39], v[38:39], v[110:111], v[110:111] op_sel_hi:[1,0,0]
    v_pk_fma_f32 v[40:41], v[40:41], v[114:115], v[114:115] op_sel_hi:[1,0,0]
    v_pk_fma_f32 v[42:43], v[42:43], v[114:115], v[114:115] op_sel_hi:[1,0,0]
    v_pk_fma_f32 v[44:45], v[44:45], v[110:111], v[110:111] op_sel_hi:[1,0,0]
    v_pk_fma_f32 v[46:47], v[46:47], v[110:111], v[110:111] op_sel_hi:[1,0,0]
    v_pk_fma_f32 v[48:49], v[48:49], v[114:115], v[114:115] op_sel_hi:[1,0,0]
    v_pk_fma_f32 v[50:51], v[50:51], v[114:115], v[114:115] op_sel_hi:[1,0,0]
    v_rcp_f32 v36, v36
    v_rcp_f32 v37, v37
    v_rcp_f32 v38, v38
    v_rcp_f32 v39, v39
    v_rcp_f32 v40, v40
    v_rcp_f32 v41, v41
    v_rcp_f32 v42, v42
    v_rcp_f32 v43, v43
    v_rcp_f32 v44, v44
    v_rcp_f32 v45, v45
    v_rcp_f32 v46, v46
    v_rcp_f32 v47, v47
    v_rcp_f32 v48, v48
    v_rcp_f32 v49, v49
    v_rcp_f32 v50, v50
    v_rcp_f32 v51, v51
    v_pk_mul_f32 v[204:205], v[204:205], v[36:37]
    v_pk_mul_f32 v[206:207], v[206:207], v[38:39]
    v_pk_mul_f32 v[208:209], v[208:209], v[40:41]
    v_pk_mul_f32 v[210:211], v[210:211], v[42:43]
    v_pk_mul_f32 v[212:213], v[212:213], v[44:45]
    v_pk_mul_f32 v[214:215], v[214:215], v[46:47]
    v_pk_mul_f32 v[216:217], v[216:217], v[48:49]
    v_pk_mul_f32 v[218:219], v[218:219], v[50:51]
    v_cvt_pk_bf16_f32 v136, v204, v205
    v_cvt_pk_bf16_f32 v137, v206, v207
    v_cvt_pk_bf16_f32 v138, v208, v209
    v_cvt_pk_bf16_f32 v139, v210, v211
    v_cvt_pk_bf16_f32 v140, v212, v213
    v_cvt_pk_bf16_f32 v141, v214, v215
    v_cvt_pk_bf16_f32 v142, v216, v217
    v_cvt_pk_bf16_f32 v143, v218, v219
    v_permlane16_swap_b32 v136, v138
    v_permlane16_swap_b32 v137, v139
    v_permlane16_swap_b32 v140, v142
    v_permlane16_swap_b32 v141, v143
    buffer_store_dwordx4 v[136:139], v2, s[36:39], s66 offen sc1
    buffer_store_dwordx4 v[140:143], v2, s[36:39], s67 offen sc1
    s_waitcnt lgkmcnt(2)
    v_lshlrev_b32 v68, 16, v100
    v_and_b32 v69, 0xffff0000, v100
    v_lshlrev_b32 v70, 16, v101
    v_and_b32 v71, 0xffff0000, v101
    v_lshlrev_b32 v72, 16, v102
    v_and_b32 v73, 0xffff0000, v102
    v_lshlrev_b32 v74, 16, v103
    v_and_b32 v75, 0xffff0000, v103
    v_pk_fma_f32 v[36:37], v[144:145], v[108:109], v[68:69] op_sel:[0,1,0] op_sel_hi:[1,1,1]
    v_pk_fma_f32 v[38:39], v[146:147], v[108:109], v[70:71] op_sel:[0,1,0] op_sel_hi:[1,1,1]
    v_pk_fma_f32 v[40:41], v[144:145], v[112:113], v[68:69] op_sel:[0,1,0] op_sel_hi:[1,1,1]
    v_pk_fma_f32 v[42:43], v[146:147], v[112:113], v[70:71] op_sel:[0,1,0] op_sel_hi:[1,1,1]
    v_pk_fma_f32 v[44:45], v[148:149], v[108:109], v[72:73] op_sel:[0,1,0] op_sel_hi:[1,1,1]
    v_pk_fma_f32 v[46:47], v[150:151], v[108:109], v[74:75] op_sel:[0,1,0] op_sel_hi:[1,1,1]
    v_pk_fma_f32 v[48:49], v[148:149], v[112:113], v[72:73] op_sel:[0,1,0] op_sel_hi:[1,1,1]
    v_pk_fma_f32 v[50:51], v[150:151], v[112:113], v[74:75] op_sel:[0,1,0] op_sel_hi:[1,1,1]
    v_pk_fma_f32 v[220:221], v[220:221], v[108:109], v[36:37] op_sel_hi:[1,0,1]
    v_pk_fma_f32 v[222:223], v[222:223], v[108:109], v[38:39] op_sel_hi:[1,0,1]
    v_pk_fma_f32 v[224:225], v[224:225], v[112:113], v[40:41] op_sel_hi:[1,0,1]
    v_pk_fma_f32 v[226:227], v[226:227], v[112:113], v[42:43] op_sel_hi:[1,0,1]
    v_pk_fma_f32 v[228:229], v[228:229], v[108:109], v[44:45] op_sel_hi:[1,0,1]
    v_pk_fma_f32 v[230:231], v[230:231], v[108:109], v[46:47] op_sel_hi:[1,0,1]
    v_pk_fma_f32 v[232:233], v[232:233], v[112:113], v[48:49] op_sel_hi:[1,0,1]
    v_pk_fma_f32 v[234:235], v[234:235], v[112:113], v[50:51] op_sel_hi:[1,0,1]
    v_pk_mul_f32 v[36:37], v[220:221], v[220:221]
    v_pk_mul_f32 v[38:39], v[222:223], v[222:223]
    v_pk_mul_f32 v[40:41], v[224:225], v[224:225]
    v_pk_mul_f32 v[42:43], v[226:227], v[226:227]
    v_pk_mul_f32 v[44:45], v[228:229], v[228:229]
    v_pk_mul_f32 v[46:47], v[230:231], v[230:231]
    v_pk_mul_f32 v[48:49], v[232:233], v[232:233]
    v_pk_mul_f32 v[50:51], v[234:235], v[234:235]
    v_pk_fma_f32 v[36:37], v[36:37], v[32:33], v[32:33] op_sel:[0,1,0] op_sel_hi:[1,1,0]
    v_pk_fma_f32 v[38:39], v[38:39], v[32:33], v[32:33] op_sel:[0,1,0] op_sel_hi:[1,1,0]
    v_pk_fma_f32 v[40:41], v[40:41], v[32:33], v[32:33] op_sel:[0,1,0] op_sel_hi:[1,1,0]
    v_pk_fma_f32 v[42:43], v[42:43], v[32:33], v[32:33] op_sel:[0,1,0] op_sel_hi:[1,1,0]
    v_pk_fma_f32 v[44:45], v[44:45], v[32:33], v[32:33] op_sel:[0,1,0] op_sel_hi:[1,1,0]
    v_pk_fma_f32 v[46:47], v[46:47], v[32:33], v[32:33] op_sel:[0,1,0] op_sel_hi:[1,1,0]
    v_pk_fma_f32 v[48:49], v[48:49], v[32:33], v[32:33] op_sel:[0,1,0] op_sel_hi:[1,1,0]
    v_pk_fma_f32 v[50:51], v[50:51], v[32:33], v[32:33] op_sel:[0,1,0] op_sel_hi:[1,1,0]
    v_pk_mul_f32 v[36:37], v[36:37], v[220:221]
    v_pk_mul_f32 v[38:39], v[38:39], v[222:223]
    v_pk_mul_f32 v[40:41], v[40:41], v[224:225]
    v_pk_mul_f32 v[42:43], v[42:43], v[226:227]
    v_pk_mul_f32 v[44:45], v[44:45], v[228:229]
    v_pk_mul_f32 v[46:47], v[46:47], v[230:231]
    v_pk_mul_f32 v[48:49], v[48:49], v[232:233]
    v_pk_mul_f32 v[50:51], v[50:51], v[234:235]
    v_exp_f32 v36, v36
    v_exp_f32 v37, v37
    v_exp_f32 v38, v38
    v_exp_f32 v39, v39
    v_exp_f32 v40, v40
    v_exp_f32 v41, v41
    v_exp_f32 v42, v42
    v_exp_f32 v43, v43
    v_exp_f32 v44, v44
    v_exp_f32 v45, v45
    v_exp_f32 v46, v46
    v_exp_f32 v47, v47
    v_exp_f32 v48, v48
    v_exp_f32 v49, v49
    v_exp_f32 v50, v50
    v_exp_f32 v51, v51
    v_pk_fma_f32 v[36:37], v[36:37], v[110:111], v[110:111] op_sel_hi:[1,0,0]
    v_pk_fma_f32 v[38:39], v[38:39], v[110:111], v[110:111] op_sel_hi:[1,0,0]
    v_pk_fma_f32 v[40:41], v[40:41], v[114:115], v[114:115] op_sel_hi:[1,0,0]
    v_pk_fma_f32 v[42:43], v[42:43], v[114:115], v[114:115] op_sel_hi:[1,0,0]
    v_pk_fma_f32 v[44:45], v[44:45], v[110:111], v[110:111] op_sel_hi:[1,0,0]
    v_pk_fma_f32 v[46:47], v[46:47], v[110:111], v[110:111] op_sel_hi:[1,0,0]
    v_pk_fma_f32 v[48:49], v[48:49], v[114:115], v[114:115] op_sel_hi:[1,0,0]
    v_pk_fma_f32 v[50:51], v[50:51], v[114:115], v[114:115] op_sel_hi:[1,0,0]
    v_rcp_f32 v36, v36
    v_rcp_f32 v37, v37
    v_rcp_f32 v38, v38
    v_rcp_f32 v39, v39
    v_rcp_f32 v40, v40
    v_rcp_f32 v41, v41
    v_rcp_f32 v42, v42
    v_rcp_f32 v43, v43
    v_rcp_f32 v44, v44
    v_rcp_f32 v45, v45
    v_rcp_f32 v46, v46
    v_rcp_f32 v47, v47
    v_rcp_f32 v48, v48
    v_rcp_f32 v49, v49
    v_rcp_f32 v50, v50
    v_rcp_f32 v51, v51
    v_pk_mul_f32 v[220:221], v[220:221], v[36:37]
    v_pk_mul_f32 v[222:223], v[222:223], v[38:39]
    v_pk_mul_f32 v[224:225], v[224:225], v[40:41]
    v_pk_mul_f32 v[226:227], v[226:227], v[42:43]
    v_pk_mul_f32 v[228:229], v[228:229], v[44:45]
    v_pk_mul_f32 v[230:231], v[230:231], v[46:47]
    v_pk_mul_f32 v[232:233], v[232:233], v[48:49]
    v_pk_mul_f32 v[234:235], v[234:235], v[50:51]
    v_cvt_pk_bf16_f32 v144, v220, v221
    v_cvt_pk_bf16_f32 v145, v222, v223
    v_cvt_pk_bf16_f32 v146, v224, v225
    v_cvt_pk_bf16_f32 v147, v226, v227
    v_cvt_pk_bf16_f32 v148, v228, v229
    v_cvt_pk_bf16_f32 v149, v230, v231
    v_cvt_pk_bf16_f32 v150, v232, v233
    v_cvt_pk_bf16_f32 v151, v234, v235
    v_permlane16_swap_b32 v144, v146
    v_permlane16_swap_b32 v145, v147
    v_permlane16_swap_b32 v148, v150
    v_permlane16_swap_b32 v149, v151
    buffer_store_dwordx4 v[144:147], v2, s[36:39], s68 offen sc1
    buffer_store_dwordx4 v[148:151], v2, s[36:39], s69 offen sc1
    s_waitcnt lgkmcnt(0)
    v_lshlrev_b32 v68, 16, v104
    v_and_b32 v69, 0xffff0000, v104
    v_lshlrev_b32 v70, 16, v105
    v_and_b32 v71, 0xffff0000, v105
    v_pk_fma_f32 v[36:37], v[152:153], v[108:109], v[68:69] op_sel:[0,1,0] op_sel_hi:[1,1,1]
    v_pk_fma_f32 v[38:39], v[154:155], v[108:109], v[70:71] op_sel:[0,1,0] op_sel_hi:[1,1,1]
    v_pk_fma_f32 v[40:41], v[152:153], v[112:113], v[68:69] op_sel:[0,1,0] op_sel_hi:[1,1,1]
    v_pk_fma_f32 v[42:43], v[154:155], v[112:113], v[70:71] op_sel:[0,1,0] op_sel_hi:[1,1,1]
    v_pk_fma_f32 v[236:237], v[236:237], v[108:109], v[36:37] op_sel_hi:[1,0,1]
    v_pk_fma_f32 v[238:239], v[238:239], v[108:109], v[38:39] op_sel_hi:[1,0,1]
    v_pk_fma_f32 v[240:241], v[240:241], v[112:113], v[40:41] op_sel_hi:[1,0,1]
    v_pk_fma_f32 v[242:243], v[242:243], v[112:113], v[42:43] op_sel_hi:[1,0,1]
    v_pk_mul_f32 v[36:37], v[236:237], v[236:237]
    v_pk_mul_f32 v[38:39], v[238:239], v[238:239]
    v_pk_mul_f32 v[40:41], v[240:241], v[240:241]
    v_pk_mul_f32 v[42:43], v[242:243], v[242:243]
    v_pk_fma_f32 v[36:37], v[36:37], v[32:33], v[32:33] op_sel:[0,1,0] op_sel_hi:[1,1,0]
    v_pk_fma_f32 v[38:39], v[38:39], v[32:33], v[32:33] op_sel:[0,1,0] op_sel_hi:[1,1,0]
    v_pk_fma_f32 v[40:41], v[40:41], v[32:33], v[32:33] op_sel:[0,1,0] op_sel_hi:[1,1,0]
    v_pk_fma_f32 v[42:43], v[42:43], v[32:33], v[32:33] op_sel:[0,1,0] op_sel_hi:[1,1,0]
    v_pk_mul_f32 v[36:37], v[36:37], v[236:237]
    v_pk_mul_f32 v[38:39], v[38:39], v[238:239]
    v_pk_mul_f32 v[40:41], v[40:41], v[240:241]
    v_pk_mul_f32 v[42:43], v[42:43], v[242:243]
    v_exp_f32 v36, v36
    v_exp_f32 v37, v37
    v_exp_f32 v38, v38
    v_exp_f32 v39, v39
    v_exp_f32 v40, v40
    v_exp_f32 v41, v41
    v_exp_f32 v42, v42
    v_exp_f32 v43, v43
    v_pk_fma_f32 v[36:37], v[36:37], v[110:111], v[110:111] op_sel_hi:[1,0,0]
    v_pk_fma_f32 v[38:39], v[38:39], v[110:111], v[110:111] op_sel_hi:[1,0,0]
    v_pk_fma_f32 v[40:41], v[40:41], v[114:115], v[114:115] op_sel_hi:[1,0,0]
    v_pk_fma_f32 v[42:43], v[42:43], v[114:115], v[114:115] op_sel_hi:[1,0,0]
    v_rcp_f32 v36, v36
    v_rcp_f32 v37, v37
    v_rcp_f32 v38, v38
    v_rcp_f32 v39, v39
    v_rcp_f32 v40, v40
    v_rcp_f32 v41, v41
    v_rcp_f32 v42, v42
    v_rcp_f32 v43, v43
    v_pk_mul_f32 v[236:237], v[236:237], v[36:37]
    v_pk_mul_f32 v[238:239], v[238:239], v[38:39]
    v_pk_mul_f32 v[240:241], v[240:241], v[40:41]
    v_pk_mul_f32 v[242:243], v[242:243], v[42:43]
    v_cvt_pk_bf16_f32 v152, v236, v237
    v_cvt_pk_bf16_f32 v153, v238, v239
    v_cvt_pk_bf16_f32 v154, v240, v241
    v_cvt_pk_bf16_f32 v155, v242, v243
    s_nop 0
    v_permlane16_swap_b32 v152, v154
    v_permlane16_swap_b32 v153, v155
    buffer_store_dwordx4 v[152:155], v2, s[36:39], s70 offen sc1
    s_mov_b64 exec, 1
    ds_add_u32 v12, v13 offset:12
    s_mov_b64 exec, -1
    s_mov_b32 s88, s22
    s_mov_b32 s89, s23
    s_mov_b32 s90, 2097152
    s_mov_b32 s91, 0x20000
    v_and_b32 v4, 1023, v10
    v_lshrrev_b32 v5, 3, v1
    s_lshl_b32 s59, s52, 7
    v_add_u32 v6, s59, v5
    v_lshl_add_u32 v14, v6, 10, v4
    v_add_u32 v15, 7168, v14
    v_lshrrev_b32 v7, 5, v1
    v_lshlrev_b32 v4, 13, v7
    v_bfe_u32 v6, v1, 2, 3
    v_lshl_add_u32 v4, v6, 7, v4
    v_and_b32 v5, 3, v5
    v_lshl_add_u32 v4, v5, 5, v4
    v_and_b32 v5, 3, v1
    v_lshl_add_u32 v4, v5, 3, v4
    s_and_b32 s59, s52, 1
    s_lshl_b32 s59, s59, 6
    v_xor_b32 v4, s59, v4
    v_add_u32 v16, s98, v4
    v_xor_b32 v17, 32, v16
    v_xor_b32 v18, 64, v16
    v_xor_b32 v19, 96, v16
    v_add_u32 v20, 49152, v16
    v_add_u32 v21, 49152, v17
    v_add_u32 v22, 49152, v18
    v_add_u32 v23, 49152, v19
    v_add_u32 v24, 49152, v20
    v_add_u32 v25, 49152, v21
    v_add_u32 v26, 49152, v22
    v_add_u32 v27, 49152, v23
    s_lshr_b32 s59, s56, 1
    s_lshl2_add_u32 s59, s59, s52
    s_lshl_b32 s59, s59, 10
    s_add_u32 s59, s59, 22085632
    s_add_u32 s74, s26, s59
    s_addc_u32 s75, s27, 0
    s_mul_i32 s59, s56, 288
    s_mul_i32 s60, s52, 28
    s_add_u32 s59, s59, s60
    s_lshl_b32 s59, s59, 10
    s_add_u32 s59, s59, 8388608
    s_add_u32 s60, s59, 147456
    s_cmp_ge_u32 s52, 2
    s_cselect_b32 s61, s60, s59
    s_cselect_b32 s62, s59, s60
    v_lshrrev_b32 v5, 4, v1
    v_and_b32 v4, 15, v1
    v_lshlrev_b32 v4, 4, v4
    v_lshl_add_u32 v4, v5, 9, v4
    v_add_u32 v28, s61, v4
    v_add_u32 v29, s62, v4
    s_and_b32 s59, s52, 1
    s_lshl1_add_u32 s59, s57, s59
    s_lshl_b32 s59, s59, 6
    s_add_u32 s59, s59, 156928
    v_lshl_add_u32 v6, v5, 3, s59
    ds_read_b64 v[32:33], v6 offset:0
    ds_read_b64 v[34:35], v6 offset:32
    ds_read_b32 v4, v12 offset:8
    s_waitcnt lgkmcnt(0)
    v_readfirstlane_b32 s59, v4
    s_mov_b32 s99, 1600000
    s_cmp_lt_u32 s59, 8
    s_cbranch_scc1 L_lw_7
L_lo_8:
    s_add_u32 m0, s98, 65536
    s_nop 0
    buffer_load_dwordx4 v10, s[40:43], s84 offen lds
    buffer_load_dwordx4 v11, s[40:43], s84 offen offset:1024 lds
    s_add_u32 s84, s84, 16384
    s_cmp_lt_u32 s84, 458752
    s_cselect_b32 s84, s84, 0
    s_add_u32 m0, s98, 73728
    s_nop 0
    buffer_load_dwordx4 v10, s[40:43], s84 offen lds
    buffer_load_dwordx4 v11, s[40:43], s84 offen offset:1024 lds
    s_add_u32 s84, s84, 16384
    s_cmp_lt_u32 s84, 458752
    s_cselect_b32 s84, s84, 0
    s_add_u32 m0, s98, 81920
    s_nop 0
    buffer_load_dwordx4 v10, s[40:43], s84 offen lds
    buffer_load_dwordx4 v11, s[40:43], s84 offen offset:1024 lds
    s_add_u32 s84, s84, 16384
    s_cmp_lt_u32 s84, 458752
    s_cselect_b32 s84, s84, 0
    s_add_u32 m0, s98, 90112
    s_nop 0
    buffer_load_dwordx4 v10, s[40:43], s84 offen lds
    buffer_load_dwordx4 v11, s[40:43], s84 offen offset:1024 lds
    s_add_u32 s84, s84, 16384
    s_cmp_lt_u32 s84, 458752
    s_cselect_b32 s84, s84, 0
    s_waitcnt vmcnt(8)
    s_sub_u32 s60, s58, s87
    s_sub_u32 s60, s60, 3
    s_cmp_eq_u32 s53, 0
    s_cselect_b32 s87, s60, 1
    s_add_u32 s59, s3, 65536
    s_atomic_add s87, s[26:27], s59
    s_setprio 0
    s_add_u32 m0, s98, 0
    s_nop 0
    buffer_load_dwordx4 v10, s[40:43], s84 offen lds
    buffer_load_dwordx4 v11, s[40:43], s84 offen offset:1024 lds
    s_add_u32 s84, s84, 16384
    s_cmp_lt_u32 s84, 458752
    s_cselect_b32 s84, s84, 0
    s_add_u32 m0, s98, 8192
    s_nop 0
    buffer_load_dwordx4 v10, s[40:43], s84 offen lds
    buffer_load_dwordx4 v11, s[40:43], s84 offen offset:1024 lds
    s_add_u32 s84, s84, 16384
    s_cmp_lt_u32 s84, 458752
    s_cselect_b32 s84, s84, 0
    s_add_u32 m0, s98, 32768
    s_nop 0
    buffer_load_dwordx4 v10, s[40:43], s84 offen lds
    buffer_load_dwordx4 v11, s[40:43], s84 offen offset:1024 lds
    s_add_u32 s84, s84, 16384
    s_cmp_lt_u32 s84, 458752
    s_cselect_b32 s84, s84, 0
    s_add_u32 m0, s98, 40960
    s_nop 0
    buffer_load_dwordx4 v10, s[40:43], s84 offen lds
    buffer_load_dwordx4 v11, s[40:43], s84 offen offset:1024 lds
    s_add_u32 s84, s84, 16384
    s_cmp_lt_u32 s84, 458752
    s_cselect_b32 s84, s84, 0
    s_add_u32 m0, s98, 49152
    s_nop 0
    buffer_load_dwordx4 v10, s[40:43], s84 offen lds
    buffer_load_dwordx4 v11, s[40:43], s84 offen offset:1024 lds
    s_add_u32 s84, s84, 16384
    s_cmp_lt_u32 s84, 458752
    s_cselect_b32 s84, s84, 0
    s_add_u32 m0, s98, 57344
    s_nop 0
    buffer_load_dwordx4 v10, s[40:43], s84 offen lds
    buffer_load_dwordx4 v11, s[40:43], s84 offen offset:1024 lds
    s_add_u32 s84, s84, 16384
    s_cmp_lt_u32 s84, 458752
    s_cselect_b32 s84, s84, 0
    s_lshl_b32 s59, s53, 2
    v_add_u32 v4, s59, v12
    ds_read_b32 v5, v4 offset:16
    s_waitcnt lgkmcnt(0)
    v_readfirstlane_b32 s59, v5
    s_mov_b32 s99, 1600000
    s_cmp_lt_u32 s59, 1
    s_cbranch_scc1 L_lw_9
L_lo_10:
    ds_read_b64_tr_b16 v[36:37], v16 offset:16384
    ds_read_b64_tr_b16 v[38:39], v16 offset:17408
    ds_read_b64_tr_b16 v[40:41], v17 offset:16384
    ds_read_b64_tr_b16 v[42:43], v17 offset:17408
    ds_read_b64_tr_b16 v[44:45], v18 offset:16384
    ds_read_b64_tr_b16 v[46:47], v18 offset:17408
    ds_read_b64_tr_b16 v[48:49], v19 offset:16384
    ds_read_b64_tr_b16 v[50:51], v19 offset:17408
    ds_read_b64_tr_b16 v[52:53], v24 offset:0
    ds_read_b64_tr_b16 v[54:55], v24 offset:1024
    ds_read_b64_tr_b16 v[56:57], v25 offset:0
    ds_read_b64_tr_b16 v[58:59], v25 offset:1024
    ds_read_b64_tr_b16 v[60:61], v26 offset:0
    ds_read_b64_tr_b16 v[62:63], v26 offset:1024
    ds_read_b64_tr_b16 v[64:65], v27 offset:0
    ds_read_b64_tr_b16 v[66:67], v27 offset:1024
    ds_read_b64_tr_b16 v[68:69], v24 offset:16384
    ds_read_b64_tr_b16 v[70:71], v24 offset:17408
    ds_read_b64_tr_b16 v[72:73], v25 offset:16384
    ds_read_b64_tr_b16 v[74:75], v25 offset:17408
    ds_read_b64_tr_b16 v[76:77], v26 offset:16384
    ds_read_b64_tr_b16 v[78:79], v26 offset:17408
    ds_read_b64_tr_b16 v[80:81], v27 offset:16384
    ds_read_b64_tr_b16 v[82:83], v27 offset:17408
    ds_read_b64_tr_b16 v[84:85], v24 offset:32768
    ds_read_b64_tr_b16 v[86:87], v24 offset:33792
    ds_read_b64_tr_b16 v[88:89], v25 offset:32768
    ds_read_b64_tr_b16 v[90:91], v25 offset:33792
    ds_read_b64_tr_b16 v[92:93], v26 offset:32768
    ds_read_b64_tr_b16 v[94:95], v26 offset:33792
    ds_read_b64_tr_b16 v[96:97], v27 offset:32768
    ds_read_b64_tr_b16 v[98:99], v27 offset:33792
    s_waitcnt lgkmcnt(15)
    s_add_u32 m0, s98, 16384
    s_nop 0
    buffer_load_dwordx4 v10, s[40:43], s84 offen lds
    buffer_load_dwordx4 v11, s[40:43], s84 offen offset:1024 lds
    s_add_u32 s84, s84, 16384
    s_cmp_lt_u32 s84, 458752
    s_cselect_b32 s84, s84, 0
    s_add_u32 m0, s98, 24576
    s_nop 0
    buffer_load_dwordx4 v10, s[40:43], s84 offen lds
    buffer_load_dwordx4 v11, s[40:43], s84 offen offset:1024 lds
    s_add_u32 s84, s84, 16384
    s_cmp_lt_u32 s84, 458752
    s_cselect_b32 s84, s84, 0
    s_add_u32 m0, s98, 98304
    s_nop 0
    buffer_load_dwordx4 v10, s[40:43], s84 offen lds
    buffer_load_dwordx4 v11, s[40:43], s84 offen offset:1024 lds
    s_add_u32 s84, s84, 16384
    s_cmp_lt_u32 s84, 458752
    s_cselect_b32 s84, s84, 0
    s_add_u32 m0, s98, 106496
    s_nop 0
    buffer_load_dwordx4 v10, s[40:43], s84 offen lds
    buffer_load_dwordx4 v11, s[40:43], s84 offen offset:1024 lds
    s_add_u32 s84, s84, 16384
    s_cmp_lt_u32 s84, 458752
    s_cselect_b32 s84, s84, 0
    s_waitcnt lgkmcnt(0)
    s_mov_b32 s92, 0
    s_atomic_add s92, s[74:75], 0 glc
    s_mov_b32 s93, 0
    s_atomic_add s93, s[74:75], 256 glc
    s_mov_b32 s94, 0
    s_atomic_add s94, s[74:75], 512 glc
    s_mov_b32 s95, 0
    s_atomic_add s95, s[74:75], 768 glc
    s_add_u32 m0, s98, 114688
    s_nop 0
    buffer_load_dwordx4 v10, s[40:43], s84 offen lds
    buffer_load_dwordx4 v11, s[40:43], s84 offen offset:1024 lds
    s_add_u32 s84, s84, 16384
    s_cmp_lt_u32 s84, 458752
    s_cselect_b32 s84, s84, 0
    s_add_u32 m0, s98, 122880
    s_nop 0
    buffer_load_dwordx4 v10, s[40:43], s84 offen lds
    buffer_load_dwordx4 v11, s[40:43], s84 offen offset:1024 lds
    s_add_u32 s84, s84, 16384
    s_cmp_lt_u32 s84, 458752
    s_cselect_b32 s84, s84, 0
    s_add_u32 m0, s98, 131072
    s_nop 0
    buffer_load_dwordx4 v10, s[40:43], s84 offen lds
    buffer_load_dwordx4 v11, s[40:43], s84 offen offset:1024 lds
    s_add_u32 s84, s84, 16384
    s_cmp_lt_u32 s84, 458752
    s_cselect_b32 s84, s84, 0
    s_add_u32 m0, s98, 139264
    s_nop 0
    buffer_load_dwordx4 v10, s[40:43], s84 offen lds
    buffer_load_dwordx4 v11, s[40:43], s84 offen offset:1024 lds
    s_add_u32 s84, s84, 16384
    s_cmp_lt_u32 s84, 458752
    s_cselect_b32 s84, s84, 0
    s_mov_b32 s99, 200000
    s_waitcnt lgkmcnt(0)
    s_xor_b32 s92, s92, s58
    s_xor_b32 s93, s93, s58
    s_xor_b32 s94, s94, s58
    s_xor_b32 s95, s95, s58
    s_or_b32 s92, s92, s93
    s_or_b32 s92, s92, s94
    s_or_b32 s92, s92, s95
    s_cbranch_scc1 L_poll_11
L_pout_12:
    buffer_load_dwordx4 v[188:191], v28, s[36:39], s85 offen offset:0 sc1
    buffer_load_dwordx4 v[192:195], v28, s[36:39], s85 offen offset:256 sc1
    buffer_load_dwordx4 v[196:199], v29, s[36:39], s85 offen offset:0 sc1
    buffer_load_dwordx4 v[200:203], v29, s[36:39], s85 offen offset:256 sc1
    s_add_u32 s85, s85, 2048
    s_cmp_lt_u32 s85, 28672
    s_cselect_b32 s85, s85, 0
    buffer_load_dwordx4 v[204:207], v28, s[36:39], s85 offen offset:0 sc1
    buffer_load_dwordx4 v[208:211], v28, s[36:39], s85 offen offset:256 sc1
    buffer_load_dwordx4 v[212:215], v29, s[36:39], s85 offen offset:0 sc1
    buffer_load_dwordx4 v[216:219], v29, s[36:39], s85 offen offset:256 sc1
    s_add_u32 s85, s85, 2048
    s_cmp_lt_u32 s85, 28672
    s_cselect_b32 s85, s85, 0
    buffer_load_dwordx4 v[220:223], v28, s[36:39], s85 offen offset:0 sc1
    buffer_load_dwordx4 v[224:227], v28, s[36:39], s85 offen offset:256 sc1
    buffer_load_dwordx4 v[228:231], v29, s[36:39], s85 offen offset:0 sc1
    buffer_load_dwordx4 v[232:235], v29, s[36:39], s85 offen offset:256 sc1
    s_add_u32 s85, s85, 2048
    s_cmp_lt_u32 s85, 28672
    s_cselect_b32 s85, s85, 0
    buffer_load_dwordx4 v[236:239], v28, s[36:39], s85 offen offset:0 sc1
    buffer_load_dwordx4 v[240:243], v28, s[36:39], s85 offen offset:256 sc1
    buffer_load_dwordx4 v[244:247], v29, s[36:39], s85 offen offset:0 sc1
    buffer_load_dwordx4 v[248:251], v29, s[36:39], s85 offen offset:256 sc1
    s_waitcnt vmcnt(14)
    v_mfma_f32_16x16x32_bf16 v[100:103], v[36:39], v[188:191], 0
    v_mfma_f32_16x16x32_bf16 v[104:107], v[36:39], v[192:195], 0
    s_waitcnt vmcnt(12)
    v_mfma_f32_16x16x32_bf16 v[132:135], v[36:39], v[196:199], 0
    v_mfma_f32_16x16x32_bf16 v[136:139], v[36:39], v[200:203], 0
    v_mfma_f32_16x16x32_bf16 v[108:111], v[40:43], v[188:191], 0
    v_mfma_f32_16x16x32_bf16 v[112:115], v[40:43], v[192:195], 0
    v_mfma_f32_16x16x32_bf16 v[140:143], v[40:43], v[196:199], 0
    v_mfma_f32_16x16x32_bf16 v[144:147], v[40:43], v[200:203], 0
    v_mfma_f32_16x16x32_bf16 v[116:119], v[44:47], v[188:191], 0
    v_mfma_f32_16x16x32_bf16 v[120:123], v[44:47], v[192:195], 0
    v_mfma_f32_16x16x32_bf16 v[148:151], v[44:47], v[196:199], 0
    v_mfma_f32_16x16x32_bf16 v[152:155], v[44:47], v[200:203], 0
    v_mfma_f32_16x16x32_bf16 v[124:127], v[48:51], v[188:191], 0
    v_mfma_f32_16x16x32_bf16 v[128:131], v[48:51], v[192:195], 0
    v_mfma_f32_16x16x32_bf16 v[156:159], v[48:51], v[196:199], 0
    v_mfma_f32_16x16x32_bf16 v[160:163], v[48:51], v[200:203], 0
    s_waitcnt vmcnt(10)
    v_mfma_f32_16x16x32_bf16 v[100:103], v[52:55], v[204:207], v[100:103]
    s_add_u32 s85, s85, 2048
    s_cmp_lt_u32 s85, 28672
    s_cselect_b32 s85, s85, 0
    v_mfma_f32_16x16x32_bf16 v[104:107], v[52:55], v[208:211], v[104:107]
    s_waitcnt vmcnt(8)
    v_mfma_f32_16x16x32_bf16 v[132:135], v[52:55], v[212:215], v[132:135]
    v_mfma_f32_16x16x32_bf16 v[136:139], v[52:55], v[216:219], v[136:139]
    buffer_load_dwordx4 v[188:191], v28, s[36:39], s85 offen offset:0 sc1
    v_mfma_f32_16x16x32_bf16 v[108:111], v[56:59], v[204:207], v[108:111]
    v_mfma_f32_16x16x32_bf16 v[112:115], v[56:59], v[208:211], v[112:115]
    v_mfma_f32_16x16x32_bf16 v[140:143], v[56:59], v[212:215], v[140:143]
    buffer_load_dwordx4 v[192:195], v28, s[36:39], s85 offen offset:256 sc1
    v_mfma_f32_16x16x32_bf16 v[144:147], v[56:59], v[216:219], v[144:147]
    v_mfma_f32_16x16x32_bf16 v[116:119], v[60:63], v[204:207], v[116:119]
    v_mfma_f32_16x16x32_bf16 v[120:123], v[60:63], v[208:211], v[120:123]
    v_mfma_f32_16x16x32_bf16 v[148:151], v[60:63], v[212:215], v[148:151]
    buffer_load_dwordx4 v[196:199], v29, s[36:39], s85 offen offset:0 sc1
    v_mfma_f32_16x16x32_bf16 v[152:155], v[60:63], v[216:219], v[152:155]
    v_mfma_f32_16x16x32_bf16 v[124:127], v[64:67], v[204:207], v[124:127]
    v_mfma_f32_16x16x32_bf16 v[128:131], v[64:67], v[208:211], v[128:131]
    buffer_load_dwordx4 v[200:203], v29, s[36:39], s85 offen offset:256 sc1
    v_mfma_f32_16x16x32_bf16 v[156:159], v[64:67], v[212:215], v[156:159]
    v_mfma_f32_16x16x32_bf16 v[160:163], v[64:67], v[216:219], v[160:163]
    s_waitcnt vmcnt(10)
    v_mfma_f32_16x16x32_bf16 v[100:103], v[68:71], v[220:223], v[100:103]
    s_add_u32 s85, s85, 2048
    s_cmp_lt_u32 s85, 28672
    s_cselect_b32 s85, s85, 0
    v_mfma_f32_16x16x32_bf16 v[104:107], v[68:71], v[224:227], v[104:107]
    s_waitcnt vmcnt(8)
    v_mfma_f32_16x16x32_bf16 v[132:135], v[68:71], v[228:231], v[132:135]
    v_mfma_f32_16x16x32_bf16 v[136:139], v[68:71], v[232:235], v[136:139]
    buffer_load_dwordx4 v[204:207], v28, s[36:39], s85 offen offset:0 sc1
    v_mfma_f32_16x16x32_bf16 v[108:111], v[72:75], v[220:223], v[108:111]
    v_mfma_f32_16x16x32_bf16 v[112:115], v[72:75], v[224:227], v[112:115]
    v_mfma_f32_16x16x32_bf16 v[140:143], v[72:75], v[228:231], v[140:143]
    buffer_load_dwordx4 v[208:211], v28, s[36:39], s85 offen offset:256 sc1
    v_mfma_f32_16x16x32_bf16 v[144:147], v[72:75], v[232:235], v[144:147]
    v_mfma_f32_16x16x32_bf16 v[116:119], v[76:79], v[220:223], v[116:119]
    v_mfma_f32_16x16x32_bf16 v[120:123], v[76:79], v[224:227], v[120:123]
    v_mfma_f32_16x16x32_bf16 v[148:151], v[76:79], v[228:231], v[148:151]
    buffer_load_dwordx4 v[212:215], v29, s[36:39], s85 offen offset:0 sc1
    v_mfma_f32_16x16x32_bf16 v[152:155], v[76:79], v[232:235], v[152:155]
    v_mfma_f32_16x16x32_bf16 v[124:127], v[80:83], v[220:223], v[124:127]
    v_mfma_f32_16x16x32_bf16 v[128:131], v[80:83], v[224:227], v[128:131]
    buffer_load_dwordx4 v[216:219], v29, s[36:39], s85 offen offset:256 sc1
    v_mfma_f32_16x16x32_bf16 v[156:159], v[80:83], v[228:231], v[156:159]
    v_mfma_f32_16x16x32_bf16 v[160:163], v[80:83], v[232:235], v[160:163]
    s_waitcnt vmcnt(10)
    v_mfma_f32_16x16x32_bf16 v[100:103], v[84:87], v[236:239], v[100:103]
    ds_read_b64_tr_b16 v[180:181], v20 offset:16384
    s_add_u32 s85, s85, 2048
    s_cmp_lt_u32 s85, 28672
    s_cselect_b32 s85, s85, 0
    v_mfma_f32_16x16x32_bf16 v[104:107], v[84:87], v[240:243], v[104:107]
    ds_read_b64_tr_b16 v[182:183], v20 offset:17408
    s_waitcnt vmcnt(8)
    v_mfma_f32_16x16x32_bf16 v[132:135], v[84:87], v[244:247], v[132:135]
    v_mfma_f32_16x16x32_bf16 v[136:139], v[84:87], v[248:251], v[136:139]
    buffer_load_dwordx4 v[220:223], v28, s[36:39], s85 offen offset:0 sc1
    v_mfma_f32_16x16x32_bf16 v[108:111], v[88:91], v[236:239], v[108:111]
    ds_read_b64_tr_b16 v[184:185], v21 offset:16384
    v_mfma_f32_16x16x32_bf16 v[112:115], v[88:91], v[240:243], v[112:115]
    ds_read_b64_tr_b16 v[186:187], v21 offset:17408
    v_mfma_f32_16x16x32_bf16 v[140:143], v[88:91], v[244:247], v[140:143]
    buffer_load_dwordx4 v[224:227], v28, s[36:39], s85 offen offset:256 sc1
    v_mfma_f32_16x16x32_bf16 v[144:147], v[88:91], v[248:251], v[144:147]
    v_mfma_f32_16x16x32_bf16 v[116:119], v[92:95], v[236:239], v[116:119]
    ds_read_b64_tr_b16 v[164:165], v22 offset:16384
    v_mfma_f32_16x16x32_bf16 v[120:123], v[92:95], v[240:243], v[120:123]
    ds_read_b64_tr_b16 v[166:167], v22 offset:17408
    v_mfma_f32_16x16x32_bf16 v[148:151], v[92:95], v[244:247], v[148:151]
    buffer_load_dwordx4 v[228:231], v29, s[36:39], s85 offen offset:0 sc1
    v_mfma_f32_16x16x32_bf16 v[152:155], v[92:95], v[248:251], v[152:155]
    v_mfma_f32_16x16x32_bf16 v[124:127], v[96:99], v[236:239], v[124:127]
    ds_read_b64_tr_b16 v[168:169], v23 offset:16384
    v_mfma_f32_16x16x32_bf16 v[128:131], v[96:99], v[240:243], v[128:131]
    ds_read_b64_tr_b16 v[170:171], v23 offset:17408
    buffer_load_dwordx4 v[232:235], v29, s[36:39], s85 offen offset:256 sc1
    v_mfma_f32_16x16x32_bf16 v[156:159], v[96:99], v[244:247], v[156:159]
    v_mfma_f32_16x16x32_bf16 v[160:163], v[96:99], v[248:251], v[160:163]
    s_waitcnt lgkmcnt(6)
    s_waitcnt vmcnt(10)
    v_mfma_f32_16x16x32_bf16 v[100:103], v[180:183], v[188:191], v[100:103]
    ds_read_b64_tr_b16 v[172:173], v20 offset:32768
    s_add_u32 s85, s85, 2048
    s_cmp_lt_u32 s85, 28672
    s_cselect_b32 s85, s85, 0
    v_mfma_f32_16x16x32_bf16 v[104:107], v[180:183], v[192:195], v[104:107]
    ds_read_b64_tr_b16 v[174:175], v20 offset:33792
    s_waitcnt vmcnt(8)
    v_mfma_f32_16x16x32_bf16 v[132:135], v[180:183], v[196:199], v[132:135]
    v_mfma_f32_16x16x32_bf16 v[136:139], v[180:183], v[200:203], v[136:139]
    buffer_load_dwordx4 v[236:239], v28, s[36:39], s85 offen offset:0 sc1
    s_waitcnt lgkmcnt(6)
    v_mfma_f32_16x16x32_bf16 v[108:111], v[184:187], v[188:191], v[108:111]
    ds_read_b64_tr_b16 v[176:177], v21 offset:32768
    v_mfma_f32_16x16x32_bf16 v[112:115], v[184:187], v[192:195], v[112:115]
    ds_read_b64_tr_b16 v[178:179], v21 offset:33792
    v_mfma_f32_16x16x32_bf16 v[140:143], v[184:187], v[196:199], v[140:143]
    buffer_load_dwordx4 v[240:243], v28, s[36:39], s85 offen offset:256 sc1
    v_mfma_f32_16x16x32_bf16 v[144:147], v[184:187], v[200:203], v[144:147]
    s_waitcnt lgkmcnt(6)
    v_mfma_f32_16x16x32_bf16 v[116:119], v[164:167], v[188:191], v[116:119]
    ds_read_b64_tr_b16 v[180:181], v22 offset:32768
    v_mfma_f32_16x16x32_bf16 v[120:123], v[164:167], v[192:195], v[120:123]
    ds_read_b64_tr_b16 v[182:183], v22 offset:33792
    v_mfma_f32_16x16x32_bf16 v[148:151], v[164:167], v[196:199], v[148:151]
    buffer_load_dwordx4 v[244:247], v29, s[36:39], s85 offen offset:0 sc1
    v_mfma_f32_16x16x32_bf16 v[152:155], v[164:167], v[200:203], v[152:155]
    s_waitcnt lgkmcnt(6)
    v_mfma_f32_16x16x32_bf16 v[124:127], v[168:171], v[188:191], v[124:127]
    ds_read_b64_tr_b16 v[184:185], v23 offset:32768
    v_mfma_f32_16x16x32_bf16 v[128:131], v[168:171], v[192:195], v[128:131]
    ds_read_b64_tr_b16 v[186:187], v23 offset:33792
    buffer_load_dwordx4 v[248:251], v29, s[36:39], s85 offen offset:256 sc1
    v_mfma_f32_16x16x32_bf16 v[156:159], v[168:171], v[196:199], v[156:159]
    v_mfma_f32_16x16x32_bf16 v[160:163], v[168:171], v[200:203], v[160:163]
    s_waitcnt lgkmcnt(6)
    s_waitcnt vmcnt(10)
    v_mfma_f32_16x16x32_bf16 v[100:103], v[172:175], v[204:207], v[100:103]
    ds_read_b64_tr_b16 v[164:165], v16 offset:0
    s_add_u32 s85, s85, 2048
    s_cmp_lt_u32 s85, 28672
    s_cselect_b32 s85, s85, 0
    v_mfma_f32_16x16x32_bf16 v[104:107], v[172:175], v[208:211], v[104:107]
    ds_read_b64_tr_b16 v[166:167], v16 offset:1024
    buffer_load_dwordx4 v[188:191], v28, s[36:39], s85 offen offset:0 sc1
    s_waitcnt vmcnt(9)
    v_mfma_f32_16x16x32_bf16 v[132:135], v[172:175], v[212:215], v[132:135]
    buffer_load_dwordx4 v[192:195], v28, s[36:39], s85 offen offset:256 sc1
    buffer_load_dwordx4 v[196:199], v29, s[36:39], s85 offen offset:0 sc1
    v_mfma_f32_16x16x32_bf16 v[136:139], v[172:175], v[216:219], v[136:139]
    s_waitcnt lgkmcnt(6)
    v_mfma_f32_16x16x32_bf16 v[108:111], v[176:179], v[204:207], v[108:111]
    ds_read_b64_tr_b16 v[168:169], v17 offset:0
    buffer_load_dwordx4 v[200:203], v29, s[36:39], s85 offen offset:256 sc1
    v_mfma_f32_16x16x32_bf16 v[112:115], v[176:179], v[208:211], v[112:115]
    ds_read_b64_tr_b16 v[170:171], v17 offset:1024
    v_lshlrev_b32 v68, 16, v32
    v_mfma_f32_16x16x32_bf16 v[140:143], v[176:179], v[212:215], v[140:143]
    v_and_b32 v69, 0xffff0000, v32
    v_lshlrev_b32 v70, 16, v33
    v_mfma_f32_16x16x32_bf16 v[144:147], v[176:179], v[216:219], v[144:147]
    s_waitcnt lgkmcnt(6)
    v_mfma_f32_16x16x32_bf16 v[116:119], v[180:183], v[204:207], v[116:119]
    ds_read_b64_tr_b16 v[172:173], v18 offset:0
    v_and_b32 v71, 0xffff0000, v33
    v_mfma_f32_16x16x32_bf16 v[120:123], v[180:183], v[208:211], v[120:123]
    ds_read_b64_tr_b16 v[174:175], v18 offset:1024
    v_lshlrev_b32 v76, 16, v34
    v_mfma_f32_16x16x32_bf16 v[148:151], v[180:183], v[212:215], v[148:151]
    v_and_b32 v77, 0xffff0000, v34
    v_lshlrev_b32 v78, 16, v35
    v_mfma_f32_16x16x32_bf16 v[152:155], v[180:183], v[216:219], v[152:155]
    s_waitcnt lgkmcnt(6)
    v_mfma_f32_16x16x32_bf16 v[124:127], v[184:187], v[204:207], v[124:127]
    ds_read_b64_tr_b16 v[176:177], v19 offset:0
    v_and_b32 v79, 0xffff0000, v35
    v_mfma_f32_16x16x32_bf16 v[128:131], v[184:187], v[208:211], v[128:131]
    ds_read_b64_tr_b16 v[178:179], v19 offset:1024
    v_add_u32 v84, s98, v2
    v_mfma_f32_16x16x32_bf16 v[156:159], v[184:187], v[212:215], v[156:159]
    v_xor_b32 v85, 2048, v84
    v_xor_b32 v86, 4096, v84
    v_mfma_f32_16x16x32_bf16 v[160:163], v[184:187], v[216:219], v[160:163]
    s_waitcnt lgkmcnt(6)
    s_waitcnt vmcnt(10)
    v_mfma_f32_16x16x32_bf16 v[100:103], v[164:167], v[220:223], v[100:103]
    ds_read_b64_tr_b16 v[180:181], v16 offset:32768
    s_add_u32 s85, s85, 2048
    s_cmp_lt_u32 s85, 28672
    s_cselect_b32 s85, s85, 0
    v_mfma_f32_16x16x32_bf16 v[104:107], v[164:167], v[224:227], v[104:107]
    ds_read_b64_tr_b16 v[182:183], v16 offset:33792
    buffer_load_dwordx4 v[204:207], v28, s[36:39], s85 offen offset:0 sc1
    s_waitcnt vmcnt(9)
    v_mfma_f32_16x16x32_bf16 v[132:135], v[164:167], v[228:231], v[132:135]
    buffer_load_dwordx4 v[208:211], v28, s[36:39], s85 offen offset:256 sc1
    buffer_load_dwordx4 v[212:215], v29, s[36:39], s85 offen offset:0 sc1
    v_mfma_f32_16x16x32_bf16 v[136:139], v[164:167], v[232:235], v[136:139]
    s_waitcnt lgkmcnt(6)
    v_mfma_f32_16x16x32_bf16 v[108:111], v[168:171], v[220:223], v[108:111]
    ds_read_b64_tr_b16 v[184:185], v17 offset:32768
    buffer_load_dwordx4 v[216:219], v29, s[36:39], s85 offen offset:256 sc1
    v_mfma_f32_16x16x32_bf16 v[112:115], v[168:171], v[224:227], v[112:115]
    ds_read_b64_tr_b16 v[186:187], v17 offset:33792
    v_xor_b32 v87, 6144, v84
    v_mfma_f32_16x16x32_bf16 v[140:143], v[168:171], v[228:231], v[140:143]
    v_and_b32 v88, 31, v1
    v_lshrrev_b32 v89, 5, v1
    v_mfma_f32_16x16x32_bf16 v[144:147], v[168:171], v[232:235], v[144:147]
    s_waitcnt lgkmcnt(6)
    v_mfma_f32_16x16x32_bf16 v[116:119], v[172:175], v[220:223], v[116:119]
    ds_read_b64_tr_b16 v[164:165], v18 offset:32768
    s_and_b32 s65, s52, 1
    v_mfma_f32_16x16x32_bf16 v[120:123], v[172:175], v[224:227], v[120:123]
    ds_read_b64_tr_b16 v[166:167], v18 offset:33792
    s_lshl_b32 s65, s65, 2
    v_mfma_f32_16x16x32_bf16 v[148:151], v[172:175], v[228:231], v[148:151]
    v_add_u32 v89, s65, v89
    v_and_b32 v90, 7, v1
    v_mfma_f32_16x16x32_bf16 v[152:155], v[172:175], v[232:235], v[152:155]
    s_waitcnt lgkmcnt(6)
    v_mfma_f32_16x16x32_bf16 v[124:127], v[176:179], v[220:223], v[124:127]
    ds_read_b64_tr_b16 v[168:169], v19 offset:32768
    v_xor_b32 v89, v89, v90
    v_mfma_f32_16x16x32_bf16 v[128:131], v[176:179], v[224:227], v[128:131]
    ds_read_b64_tr_b16 v[170:171], v19 offset:33792
    v_lshlrev_b32 v89, 4, v89
    v_mfma_f32_16x16x32_bf16 v[156:159], v[176:179], v[228:231], v[156:159]
    v_lshl_add_u32 v89, v88, 7, v89
    s_lshr_b32 s64, s52, 1
    v_mfma_f32_16x16x32_bf16 v[160:163], v[176:179], v[232:235], v[160:163]
    s_waitcnt lgkmcnt(6)
    s_waitcnt vmcnt(10)
    v_mfma_f32_16x16x32_bf16 v[100:103], v[180:183], v[236:239], v[100:103]
    ds_read_b64_tr_b16 v[172:173], v20 offset:0
    s_add_u32 s85, s85, 2048
    s_cmp_lt_u32 s85, 28672
    s_cselect_b32 s85, s85, 0
    v_mfma_f32_16x16x32_bf16 v[104:107], v[180:183], v[240:243], v[104:107]
    ds_read_b64_tr_b16 v[174:175], v20 offset:1024
    s_add_u32 m0, s98, 65536
    s_waitcnt vmcnt(8)
    v_mfma_f32_16x16x32_bf16 v[132:135], v[180:183], v[244:247], v[132:135]
    buffer_load_dwordx4 v10, s[40:43], s84 offen lds
    buffer_load_dwordx4 v[220:223], v28, s[36:39], s85 offen offset:0 sc1
    v_mfma_f32_16x16x32_bf16 v[136:139], v[180:183], v[248:251], v[136:139]
    s_waitcnt lgkmcnt(6)
    v_mfma_f32_16x16x32_bf16 v[108:111], v[184:187], v[236:239], v[108:111]
    ds_read_b64_tr_b16 v[176:177], v21 offset:0
    buffer_load_dwordx4 v11, s[40:43], s84 offen offset:1024 lds
    v_mfma_f32_16x16x32_bf16 v[112:115], v[184:187], v[240:243], v[112:115]
    ds_read_b64_tr_b16 v[178:179], v21 offset:1024
    s_add_u32 s84, s84, 16384
    s_cmp_lt_u32 s84, 458752
    s_cselect_b32 s84, s84, 0
    v_mfma_f32_16x16x32_bf16 v[140:143], v[184:187], v[244:247], v[140:143]
    buffer_load_dwordx4 v[224:227], v28, s[36:39], s85 offen offset:256 sc1
    buffer_load_dwordx4 v[228:231], v29, s[36:39], s85 offen offset:0 sc1
    v_mfma_f32_16x16x32_bf16 v[144:147], v[184:187], v[248:251], v[144:147]
    s_waitcnt lgkmcnt(6)
    v_mfma_f32_16x16x32_bf16 v[116:119], v[164:167], v[236:239], v[116:119]
    ds_read_b64_tr_b16 v[180:181], v22 offset:0
    buffer_load_dwordx4 v[232:235], v29, s[36:39], s85 offen offset:256 sc1
    v_mfma_f32_16x16x32_bf16 v[120:123], v[164:167], v[240:243], v[120:123]
    ds_read_b64_tr_b16 v[182:183], v22 offset:1024
    s_lshl_b32 s64, s64, 12
    v_mfma_f32_16x16x32_bf16 v[148:151], v[164:167], v[244:247], v[148:151]
    s_add_u32 s64, s64, 65536
    v_add_u32 v89, s64, v89
    v_mfma_f32_16x16x32_bf16 v[152:155], v[164:167], v[248:251], v[152:155]
    s_waitcnt lgkmcnt(6)
    v_mfma_f32_16x16x32_bf16 v[124:127], v[168:171], v[236:239], v[124:127]
    ds_read_b64_tr_b16 v[184:185], v23 offset:0
    v_xor_b32 v91, 32, v89
    v_mfma_f32_16x16x32_bf16 v[128:131], v[168:171], v[240:243], v[128:131]
    ds_read_b64_tr_b16 v[186:187], v23 offset:1024
    v_lshrrev_b32 v88, 3, v1
    v_mfma_f32_16x16x32_bf16 v[156:159], v[168:171], v[244:247], v[156:159]
    v_xor_b32 v92, v88, v90
    v_lshlrev_b32 v92, 4, v92
    v_mfma_f32_16x16x32_bf16 v[160:163], v[168:171], v[248:251], v[160:163]
    s_waitcnt lgkmcnt(6)
    s_waitcnt vmcnt(12)
    v_mfma_f32_16x16x32_bf16 v[100:103], v[172:175], v[188:191], v[100:103]
    ds_read_b64_tr_b16 v[164:165], v16 offset:16384
    s_add_u32 s85, s85, 2048
    s_cmp_lt_u32 s85, 28672
    s_cselect_b32 s85, s85, 0
    v_mfma_f32_16x16x32_bf16 v[104:107], v[172:175], v[192:195], v[104:107]
    ds_read_b64_tr_b16 v[166:167], v16 offset:17408
    s_add_u32 m0, s98, 73728
    s_waitcnt vmcnt(10)
    v_mfma_f32_16x16x32_bf16 v[132:135], v[172:175], v[196:199], v[132:135]
    buffer_load_dwordx4 v10, s[40:43], s84 offen lds
    buffer_load_dwordx4 v[236:239], v28, s[36:39], s85 offen offset:0 sc1
    v_mfma_f32_16x16x32_bf16 v[136:139], v[172:175], v[200:203], v[136:139]
    s_waitcnt lgkmcnt(6)
    v_mfma_f32_16x16x32_bf16 v[108:111], v[176:179], v[188:191], v[108:111]
    ds_read_b64_tr_b16 v[168:169], v17 offset:16384
    buffer_load_dwordx4 v11, s[40:43], s84 offen offset:1024 lds
    v_mfma_f32_16x16x32_bf16 v[112:115], v[176:179], v[192:195], v[112:115]
    ds_read_b64_tr_b16 v[170:171], v17 offset:17408
    s_add_u32 m0, s98, 81920
    v_mfma_f32_16x16x32_bf16 v[140:143], v[176:179], v[196:199], v[140:143]
    buffer_load_dwordx4 v[240:243], v28, s[36:39], s85 offen offset:256 sc1
    s_add_u32 s63, s86, 0
    v_mfma_f32_16x16x32_bf16 v[144:147], v[176:179], v[200:203], v[144:147]
    s_waitcnt lgkmcnt(6)
    v_mfma_f32_16x16x32_bf16 v[116:119], v[180:183], v[188:191], v[116:119]
    ds_read_b64_tr_b16 v[172:173], v18 offset:16384
    s_and_b32 s63, s63, 7
    v_mfma_f32_16x16x32_bf16 v[120:123], v[180:183], v[192:195], v[120:123]
    ds_read_b64_tr_b16 v[174:175], v18 offset:17408
    buffer_load_dwordx4 v[244:247], v29, s[36:39], s85 offen offset:0 sc1
    v_mfma_f32_16x16x32_bf16 v[148:151], v[180:183], v[196:199], v[148:151]
    s_lshl_b32 s63, s63, 14
    buffer_load_dwordx4 v14, s[44:47], s63 offen lds
    v_mfma_f32_16x16x32_bf16 v[152:155], v[180:183], v[200:203], v[152:155]
    s_waitcnt lgkmcnt(6)
    v_mfma_f32_16x16x32_bf16 v[124:127], v[184:187], v[188:191], v[124:127]
    ds_read_b64_tr_b16 v[176:177], v19 offset:16384
    buffer_load_dwordx4 v[248:251], v29, s[36:39], s85 offen offset:256 sc1
    v_mfma_f32_16x16x32_bf16 v[128:131], v[184:187], v[192:195], v[128:131]
    ds_read_b64_tr_b16 v[178:179], v19 offset:17408
    buffer_load_dwordx4 v15, s[44:47], s63 offen offset:1024 lds
    v_mfma_f32_16x16x32_bf16 v[156:159], v[184:187], v[196:199], v[156:159]
    v_lshl_add_u32 v92, v88, 7, v92
    s_add_u32 s64, s98, 65536
    v_mfma_f32_16x16x32_bf16 v[160:163], v[184:187], v[200:203], v[160:163]
    s_waitcnt lgkmcnt(6)
    s_waitcnt vmcnt(16)
    v_mfma_f32_16x16x32_bf16 v[100:103], v[164:167], v[204:207], v[100:103]
    ds_read_b64_tr_b16 v[180:181], v24 offset:0
    s_add_u32 s85, s85, 2048
    s_cmp_lt_u32 s85, 28672
    s_cselect_b32 s85, s85, 0
    v_mfma_f32_16x16x32_bf16 v[104:107], v[164:167], v[208:211], v[104:107]
    ds_read_b64_tr_b16 v[182:183], v24 offset:1024
    s_add_u32 m0, s98, 90112
    s_waitcnt vmcnt(14)
    v_mfma_f32_16x16x32_bf16 v[132:135], v[164:167], v[212:215], v[132:135]
    s_add_u32 s63, s86, 1
    buffer_load_dwordx4 v[188:191], v28, s[36:39], s85 offen offset:0 sc1
    v_mfma_f32_16x16x32_bf16 v[136:139], v[164:167], v[216:219], v[136:139]
    s_and_b32 s63, s63, 7
    s_waitcnt lgkmcnt(6)
    v_mfma_f32_16x16x32_bf16 v[108:111], v[168:171], v[204:207], v[108:111]
    ds_read_b64_tr_b16 v[184:185], v25 offset:0
    s_lshl_b32 s63, s63, 14
    v_mfma_f32_16x16x32_bf16 v[112:115], v[168:171], v[208:211], v[112:115]
    ds_read_b64_tr_b16 v[186:187], v25 offset:1024
    buffer_load_dwordx4 v[192:195], v28, s[36:39], s85 offen offset:256 sc1
    v_mfma_f32_16x16x32_bf16 v[140:143], v[168:171], v[212:215], v[140:143]
    buffer_load_dwordx4 v14, s[44:47], s63 offen lds
    buffer_load_dwordx4 v15, s[44:47], s63 offen offset:1024 lds
    v_mfma_f32_16x16x32_bf16 v[144:147], v[168:171], v[216:219], v[144:147]
    s_waitcnt lgkmcnt(6)
    v_mfma_f32_16x16x32_bf16 v[116:119], v[172:175], v[204:207], v[116:119]
    ds_read_b64_tr_b16 v[164:165], v26 offset:0
    buffer_load_dwordx4 v[196:199], v29, s[36:39], s85 offen offset:0 sc1
    v_mfma_f32_16x16x32_bf16 v[120:123], v[172:175], v[208:211], v[120:123]
    ds_read_b64_tr_b16 v[166:167], v26 offset:1024
    s_add_u32 m0, s98, 0
    v_mfma_f32_16x16x32_bf16 v[148:151], v[172:175], v[212:215], v[148:151]
    s_add_u32 s63, s86, 2
    buffer_load_dwordx4 v[200:203], v29, s[36:39], s85 offen offset:256 sc1
    v_mfma_f32_16x16x32_bf16 v[152:155], v[172:175], v[216:219], v[152:155]
    s_and_b32 s63, s63, 7
    s_waitcnt lgkmcnt(6)
    v_mfma_f32_16x16x32_bf16 v[124:127], v[176:179], v[204:207], v[124:127]
    ds_read_b64_tr_b16 v[168:169], v27 offset:0
    s_lshl_b32 s63, s63, 14
    v_mfma_f32_16x16x32_bf16 v[128:131], v[176:179], v[208:211], v[128:131]
    ds_read_b64_tr_b16 v[170:171], v27 offset:1024
    buffer_load_dwordx4 v14, s[44:47], s63 offen lds
    v_mfma_f32_16x16x32_bf16 v[156:159], v[176:179], v[212:215], v[156:159]
    buffer_load_dwordx4 v15, s[44:47], s63 offen offset:1024 lds
    s_mov_b32 s92, 0
    s_atomic_add s92, s[74:75], 65536 glc
    s_mov_b32 s93, 0
    s_atomic_add s93, s[74:75], 65792 glc
    s_mov_b32 s94, 0
    s_atomic_add s94, s[74:75], 66048 glc
    s_mov_b32 s95, 0
    s_atomic_add s95, s[74:75], 66304 glc
    v_mfma_f32_16x16x32_bf16 v[160:163], v[176:179], v[216:219], v[160:163]
    s_waitcnt lgkmcnt(6)
    s_waitcnt vmcnt(18)
    v_mfma_f32_16x16x32_bf16 v[100:103], v[180:183], v[220:223], v[100:103]
    ds_read_b64_tr_b16 v[172:173], v24 offset:16384
    s_add_u32 s85, s85, 2048
    s_cmp_lt_u32 s85, 28672
    s_cselect_b32 s85, s85, 0
    v_mfma_f32_16x16x32_bf16 v[104:107], v[180:183], v[224:227], v[104:107]
    ds_read_b64_tr_b16 v[174:175], v24 offset:17408
    s_add_u32 m0, s98, 8192
    s_waitcnt vmcnt(16)
    v_mfma_f32_16x16x32_bf16 v[132:135], v[180:183], v[228:231], v[132:135]
    s_add_u32 s63, s86, 3
    buffer_load_dwordx4 v[204:207], v28, s[36:39], s85 offen offset:0 sc1
    v_mfma_f32_16x16x32_bf16 v[136:139], v[180:183], v[232:235], v[136:139]
    s_and_b32 s63, s63, 7
    s_waitcnt lgkmcnt(6)
    v_mfma_f32_16x16x32_bf16 v[108:111], v[184:187], v[220:223], v[108:111]
    ds_read_b64_tr_b16 v[176:177], v25 offset:16384
    s_lshl_b32 s63, s63, 14
    v_mfma_f32_16x16x32_bf16 v[112:115], v[184:187], v[224:227], v[112:115]
    ds_read_b64_tr_b16 v[178:179], v25 offset:17408
    v_mfma_f32_16x16x32_bf16 v[140:143], v[184:187], v[228:231], v[140:143]
    buffer_load_dwordx4 v[208:211], v28, s[36:39], s85 offen offset:256 sc1
    buffer_load_dwordx4 v14, s[44:47], s63 offen lds
    v_mfma_f32_16x16x32_bf16 v[144:147], v[184:187], v[232:235], v[144:147]
    buffer_load_dwordx4 v15, s[44:47], s63 offen offset:1024 lds
    s_waitcnt lgkmcnt(6)
    v_mfma_f32_16x16x32_bf16 v[116:119], v[164:167], v[220:223], v[116:119]
    ds_read_b64_tr_b16 v[180:181], v26 offset:16384
    buffer_load_dwordx4 v[212:215], v29, s[36:39], s85 offen offset:0 sc1
    v_mfma_f32_16x16x32_bf16 v[120:123], v[164:167], v[224:227], v[120:123]
    ds_read_b64_tr_b16 v[182:183], v26 offset:17408
    s_add_u32 m0, s98, 32768
    v_mfma_f32_16x16x32_bf16 v[148:151], v[164:167], v[228:231], v[148:151]
    s_add_u32 s63, s86, 4
    v_mfma_f32_16x16x32_bf16 v[152:155], v[164:167], v[232:235], v[152:155]
    buffer_load_dwordx4 v[216:219], v29, s[36:39], s85 offen offset:256 sc1
    s_waitcnt lgkmcnt(6)
    v_mfma_f32_16x16x32_bf16 v[124:127], v[168:171], v[220:223], v[124:127]
    ds_read_b64_tr_b16 v[184:185], v27 offset:16384
    s_and_b32 s63, s63, 7
    v_mfma_f32_16x16x32_bf16 v[128:131], v[168:171], v[224:227], v[128:131]
    ds_read_b64_tr_b16 v[186:187], v27 offset:17408
    s_lshl_b32 s63, s63, 14
    v_mfma_f32_16x16x32_bf16 v[156:159], v[168:171], v[228:231], v[156:159]
    buffer_load_dwordx4 v14, s[44:47], s63 offen lds
    buffer_load_dwordx4 v15, s[44:47], s63 offen offset:1024 lds
    v_mfma_f32_16x16x32_bf16 v[160:163], v[168:171], v[232:235], v[160:163]
    s_waitcnt lgkmcnt(6)
    s_waitcnt vmcnt(20)
    v_mfma_f32_16x16x32_bf16 v[100:103], v[172:175], v[236:239], v[100:103]
    ds_read_b64_tr_b16 v[164:165], v24 offset:32768
    s_mov_b32 s99, 200000
    s_waitcnt lgkmcnt(0)
    s_xor_b32 s92, s92, s58
    s_xor_b32 s93, s93, s58
    s_xor_b32 s94, s94, s58
    s_xor_b32 s95, s95, s58
    s_or_b32 s92, s92, s93
    s_or_b32 s92, s92, s94
    s_or_b32 s92, s92, s95
    s_cbranch_scc1 L_poll_13
L_pout_14:
    s_lshr_b32 s59, s52, 1
    s_lshl1_add_u32 s59, s56, s59
    s_lshl_b32 s59, s59, 7
    s_lshl_b32 s60, s52, 13
    s_add_u32 s59, s59, s60
    s_add_u32 s59, s59, 20971520
    v_and_b32 v4, 15, v1
    v_lshlrev_b32 v4, 2, v4
    buffer_load_dword v30, v4, s[36:39], s59 offen sc1
    buffer_load_dword v31, v4, s[36:39], s59 offen offset:64 sc1
    v_mfma_f32_16x16x32_bf16 v[104:107], v[172:175], v[240:243], v[104:107]
    ds_read_b64_tr_b16 v[166:167], v24 offset:33792
    s_add_u32 m0, s98, 40960
    s_waitcnt vmcnt(19)
    v_mfma_f32_16x16x32_bf16 v[132:135], v[172:175], v[244:247], v[132:135]
    s_add_u32 s63, s86, 5
    s_mul_i32 s59, s52, -20480
    s_add_u32 s59, s59, 114688
    v_add_u32 v28, s59, v28
    v_add_u32 v29, s59, v29
    s_add_u32 s85, s86, 0
    s_and_b32 s85, s85, 7
    s_lshl_b32 s85, s85, 10
    v_mfma_f32_16x16x32_bf16 v[136:139], v[172:175], v[248:251], v[136:139]
    s_and_b32 s63, s63, 7
    v_mfma_f32_16x16x32_bf16 v[108:111], v[176:179], v[236:239], v[108:111]
    ds_read_b64_tr_b16 v[168:169], v25 offset:32768
    s_lshl_b32 s63, s63, 14
    v_mfma_f32_16x16x32_bf16 v[112:115], v[176:179], v[240:243], v[112:115]
    ds_read_b64_tr_b16 v[170:171], v25 offset:33792
    buffer_load_dwordx4 v[220:223], v28, s[36:39], s85 offen offset:0 sc1
    v_mfma_f32_16x16x32_bf16 v[140:143], v[176:179], v[244:247], v[140:143]
    buffer_load_dwordx4 v14, s[44:47], s63 offen lds
    buffer_load_dwordx4 v15, s[44:47], s63 offen offset:1024 lds
    v_mfma_f32_16x16x32_bf16 v[144:147], v[176:179], v[248:251], v[144:147]
    v_mfma_f32_16x16x32_bf16 v[116:119], v[180:183], v[236:239], v[116:119]
    ds_read_b64_tr_b16 v[172:173], v26 offset:32768
    buffer_load_dwordx4 v[224:227], v28, s[36:39], s85 offen offset:256 sc1
    v_mfma_f32_16x16x32_bf16 v[120:123], v[180:183], v[240:243], v[120:123]
    ds_read_b64_tr_b16 v[174:175], v26 offset:33792
    s_add_u32 m0, s98, 49152
    v_mfma_f32_16x16x32_bf16 v[148:151], v[180:183], v[244:247], v[148:151]
    s_add_u32 s63, s86, 6
    buffer_load_dwordx4 v[228:231], v29, s[36:39], s85 offen offset:0 sc1
    v_mfma_f32_16x16x32_bf16 v[152:155], v[180:183], v[248:251], v[152:155]
    s_and_b32 s63, s63, 7
    v_mfma_f32_16x16x32_bf16 v[124:127], v[184:187], v[236:239], v[124:127]
    ds_read_b64_tr_b16 v[176:177], v27 offset:32768
    s_lshl_b32 s63, s63, 14
    v_mfma_f32_16x16x32_bf16 v[128:131], v[184:187], v[240:243], v[128:131]
    ds_read_b64_tr_b16 v[178:179], v27 offset:33792
    buffer_load_dwordx4 v[232:235], v29, s[36:39], s85 offen offset:256 sc1
    v_mfma_f32_16x16x32_bf16 v[156:159], v[184:187], v[244:247], v[156:159]
    buffer_load_dwordx4 v14, s[44:47], s63 offen lds
    buffer_load_dwordx4 v15, s[44:47], s63 offen offset:1024 lds
    v_mfma_f32_16x16x32_bf16 v[160:163], v[184:187], v[248:251], v[160:163]
    s_waitcnt lgkmcnt(6)
    s_waitcnt vmcnt(24)
    v_mfma_f32_16x16x32_bf16 v[100:103], v[164:167], v[188:191], v[100:103]
    ds_read_b64_tr_b16 v[180:181], v20 offset:16384
    s_add_u32 s85, s86, 2
    s_and_b32 s85, s85, 7
    s_lshl_b32 s85, s85, 10
    v_mfma_f32_16x16x32_bf16 v[104:107], v[164:167], v[192:195], v[104:107]
    ds_read_b64_tr_b16 v[182:183], v20 offset:17408
    s_add_u32 m0, s98, 57344
    s_waitcnt vmcnt(20)
    v_mfma_f32_16x16x32_bf16 v[132:135], v[164:167], v[196:199], v[132:135]
    s_add_u32 s63, s86, 7
    buffer_load_dwordx4 v[236:239], v28, s[36:39], s85 offen offset:0 sc1
    v_mfma_f32_16x16x32_bf16 v[136:139], v[164:167], v[200:203], v[136:139]
    s_waitcnt lgkmcnt(6)
    v_mfma_f32_16x16x32_bf16 v[108:111], v[168:171], v[188:191], v[108:111]
    ds_read_b64_tr_b16 v[184:185], v21 offset:16384
    s_and_b32 s63, s63, 7
    v_mfma_f32_16x16x32_bf16 v[112:115], v[168:171], v[192:195], v[112:115]
    ds_read_b64_tr_b16 v[186:187], v21 offset:17408
    s_lshl_b32 s63, s63, 14
    v_mfma_f32_16x16x32_bf16 v[140:143], v[168:171], v[196:199], v[140:143]
    buffer_load_dwordx4 v[240:243], v28, s[36:39], s85 offen offset:256 sc1
    buffer_load_dwordx4 v14, s[44:47], s63 offen lds
    v_mfma_f32_16x16x32_bf16 v[144:147], v[168:171], v[200:203], v[144:147]
    s_waitcnt lgkmcnt(6)
    v_mfma_f32_16x16x32_bf16 v[116:119], v[172:175], v[188:191], v[116:119]
    ds_read_b64_tr_b16 v[164:165], v22 offset:16384
    buffer_load_dwordx4 v15, s[44:47], s63 offen offset:1024 lds
    v_mfma_f32_16x16x32_bf16 v[120:123], v[172:175], v[192:195], v[120:123]
    ds_read_b64_tr_b16 v[166:167], v22 offset:17408
    buffer_load_dwordx4 v[244:247], v29, s[36:39], s85 offen offset:0 sc1
    v_mfma_f32_16x16x32_bf16 v[148:151], v[172:175], v[196:199], v[148:151]
    buffer_load_dwordx4 v[248:251], v29, s[36:39], s85 offen offset:256 sc1
    v_add_u32 v92, s64, v92
    v_mfma_f32_16x16x32_bf16 v[152:155], v[172:175], v[200:203], v[152:155]
    s_waitcnt lgkmcnt(6)
    v_mfma_f32_16x16x32_bf16 v[124:127], v[176:179], v[188:191], v[124:127]
    ds_read_b64_tr_b16 v[168:169], v23 offset:16384
    v_lshlrev_b32 v88, 10, v88
    v_mfma_f32_16x16x32_bf16 v[128:131], v[176:179], v[192:195], v[128:131]
    ds_read_b64_tr_b16 v[170:171], v23 offset:17408
    v_lshl_add_u32 v88, v90, 4, v88
    v_mfma_f32_16x16x32_bf16 v[156:159], v[176:179], v[196:199], v[156:159]
    s_lshl2_add_u32 s64, s56, s52
    s_lshl_b32 s64, s64, 14
    v_mfma_f32_16x16x32_bf16 v[160:163], v[176:179], v[200:203], v[160:163]
    s_waitcnt lgkmcnt(6)
    s_waitcnt vmcnt(22)
    v_mfma_f32_16x16x32_bf16 v[100:103], v[180:183], v[204:207], v[100:103]
    ds_read_b64_tr_b16 v[172:173], v20 offset:32768
    s_add_u32 s85, s86, 4
    s_and_b32 s85, s85, 7
    s_lshl_b32 s85, s85, 10
    v_mfma_f32_16x16x32_bf16 v[104:107], v[180:183], v[208:211], v[104:107]
    ds_read_b64_tr_b16 v[174:175], v20 offset:33792
    s_waitcnt vmcnt(18)
    v_mfma_f32_16x16x32_bf16 v[132:135], v[180:183], v[212:215], v[132:135]
    buffer_load_dwordx4 v[188:191], v28, s[36:39], s85 offen offset:0 sc1
    v_mfma_f32_16x16x32_bf16 v[136:139], v[180:183], v[216:219], v[136:139]
    s_waitcnt lgkmcnt(6)
    v_mfma_f32_16x16x32_bf16 v[108:111], v[184:187], v[204:207], v[108:111]
    ds_read_b64_tr_b16 v[176:177], v21 offset:32768
    buffer_load_dwordx4 v[192:195], v28, s[36:39], s85 offen offset:256 sc1
    v_mfma_f32_16x16x32_bf16 v[112:115], v[184:187], v[208:211], v[112:115]
    ds_read_b64_tr_b16 v[178:179], v21 offset:33792
    v_mfma_f32_16x16x32_bf16 v[140:143], v[184:187], v[212:215], v[140:143]
    buffer_load_dwordx4 v[196:199], v29, s[36:39], s85 offen offset:0 sc1
    v_mfma_f32_16x16x32_bf16 v[144:147], v[184:187], v[216:219], v[144:147]
    s_waitcnt lgkmcnt(6)
    v_mfma_f32_16x16x32_bf16 v[116:119], v[164:167], v[204:207], v[116:119]
    ds_read_b64_tr_b16 v[180:181], v22 offset:32768
    buffer_load_dwordx4 v[200:203], v29, s[36:39], s85 offen offset:256 sc1
    v_mfma_f32_16x16x32_bf16 v[120:123], v[164:167], v[208:211], v[120:123]
    ds_read_b64_tr_b16 v[182:183], v22 offset:33792
    v_mfma_f32_16x16x32_bf16 v[148:151], v[164:167], v[212:215], v[148:151]
    s_lshl_b32 s65, s57, 7
    v_mfma_f32_16x16x32_bf16 v[152:155], v[164:167], v[216:219], v[152:155]
    s_waitcnt lgkmcnt(6)
    v_mfma_f32_16x16x32_bf16 v[124:127], v[168:171], v[204:207], v[124:127]
    ds_read_b64_tr_b16 v[184:185], v23 offset:32768
    s_add_u32 s64, s64, s65
    v_mfma_f32_16x16x32_bf16 v[128:131], v[168:171], v[208:211], v[128:131]
    ds_read_b64_tr_b16 v[186:187], v23 offset:33792
    v_mfma_f32_16x16x32_bf16 v[156:159], v[168:171], v[212:215], v[156:159]
    s_add_u32 s65, s64, 8192
    v_mfma_f32_16x16x32_bf16 v[160:163], v[168:171], v[216:219], v[160:163]
    s_waitcnt lgkmcnt(6)
    s_waitcnt vmcnt(14)
    v_mfma_f32_16x16x32_bf16 v[100:103], v[172:175], v[220:223], v[100:103]
    ds_read_b64_tr_b16 v[164:165], v16 offset:0
    s_add_u32 s85, s86, 6
    s_and_b32 s85, s85, 7
    s_lshl_b32 s85, s85, 10
    v_mfma_f32_16x16x32_bf16 v[104:107], v[172:175], v[224:227], v[104:107]
    ds_read_b64_tr_b16 v[166:167], v16 offset:1024
    s_waitcnt vmcnt(12)
    v_mfma_f32_16x16x32_bf16 v[132:135], v[172:175], v[228:231], v[132:135]
    v_mfma_f32_16x16x32_bf16 v[136:139], v[172:175], v[232:235], v[136:139]
    buffer_load_dwordx4 v[204:207], v28, s[36:39], s85 offen offset:0 sc1
    s_waitcnt lgkmcnt(6)
    v_mfma_f32_16x16x32_bf16 v[108:111], v[176:179], v[220:223], v[108:111]
    ds_read_b64_tr_b16 v[168:169], v17 offset:0
    v_mfma_f32_16x16x32_bf16 v[112:115], v[176:179], v[224:227], v[112:115]
    ds_read_b64_tr_b16 v[170:171], v17 offset:1024
    v_mfma_f32_16x16x32_bf16 v[140:143], v[176:179], v[228:231], v[140:143]
    buffer_load_dwordx4 v[208:211], v28, s[36:39], s85 offen offset:256 sc1
    v_mfma_f32_16x16x32_bf16 v[144:147], v[176:179], v[232:235], v[144:147]
    s_waitcnt lgkmcnt(6)
    v_mfma_f32_16x16x32_bf16 v[116:119], v[180:183], v[220:223], v[116:119]
    ds_read_b64_tr_b16 v[172:173], v18 offset:0
    v_mfma_f32_16x16x32_bf16 v[120:123], v[180:183], v[224:227], v[120:123]
    ds_read_b64_tr_b16 v[174:175], v18 offset:1024
    v_mfma_f32_16x16x32_bf16 v[148:151], v[180:183], v[228:231], v[148:151]
    buffer_load_dwordx4 v[212:215], v29, s[36:39], s85 offen offset:0 sc1
    v_mfma_f32_16x16x32_bf16 v[152:155], v[180:183], v[232:235], v[152:155]
    s_waitcnt lgkmcnt(6)
    v_mfma_f32_16x16x32_bf16 v[124:127], v[184:187], v[220:223], v[124:127]
    ds_read_b64_tr_b16 v[176:177], v19 offset:0
    v_mfma_f32_16x16x32_bf16 v[128:131], v[184:187], v[224:227], v[128:131]
    ds_read_b64_tr_b16 v[178:179], v19 offset:1024
    buffer_load_dwordx4 v[216:219], v29, s[36:39], s85 offen offset:256 sc1
    v_mfma_f32_16x16x32_bf16 v[156:159], v[184:187], v[228:231], v[156:159]
    v_mfma_f32_16x16x32_bf16 v[160:163], v[184:187], v[232:235], v[160:163]
    s_waitcnt lgkmcnt(6)
    s_waitcnt vmcnt(12)
    v_mfma_f32_16x16x32_bf16 v[100:103], v[164:167], v[236:239], v[100:103]
    ds_read_b64_tr_b16 v[36:37], v16 offset:32768
    v_mfma_f32_16x16x32_bf16 v[104:107], v[164:167], v[240:243], v[104:107]
    ds_read_b64_tr_b16 v[38:39], v16 offset:33792
    s_waitcnt vmcnt(8)
    v_mfma_f32_16x16x32_bf16 v[132:135], v[164:167], v[244:247], v[132:135]
    v_mfma_f32_16x16x32_bf16 v[136:139], v[164:167], v[248:251], v[136:139]
    s_waitcnt lgkmcnt(6)
    v_mfma_f32_16x16x32_bf16 v[108:111], v[168:171], v[236:239], v[108:111]
    ds_read_b64_tr_b16 v[40:41], v17 offset:32768
    v_mfma_f32_16x16x32_bf16 v[112:115], v[168:171], v[240:243], v[112:115]
    ds_read_b64_tr_b16 v[42:43], v17 offset:33792
    v_mfma_f32_16x16x32_bf16 v[140:143], v[168:171], v[244:247], v[140:143]
    v_mfma_f32_16x16x32_bf16 v[144:147], v[168:171], v[248:251], v[144:147]
    s_waitcnt lgkmcnt(6)
    v_mfma_f32_16x16x32_bf16 v[116:119], v[172:175], v[236:239], v[116:119]
    ds_read_b64_tr_b16 v[44:45], v18 offset:32768
    ds_read_b64_tr_b16 v[46:47], v18 offset:33792
    ds_read_b64_tr_b16 v[48:49], v19 offset:32768
    ds_read_b64_tr_b16 v[50:51], v19 offset:33792
    v_mfma_f32_16x16x32_bf16 v[120:123], v[172:175], v[240:243], v[120:123]
    ds_read_b64_tr_b16 v[52:53], v20 offset:0
    ds_read_b64_tr_b16 v[54:55], v20 offset:1024
    ds_read_b64_tr_b16 v[56:57], v21 offset:0
    ds_read_b64_tr_b16 v[58:59], v21 offset:1024
    v_mfma_f32_16x16x32_bf16 v[148:151], v[172:175], v[244:247], v[148:151]
    v_mfma_f32_16x16x32_bf16 v[152:155], v[172:175], v[248:251], v[152:155]
    s_waitcnt lgkmcnt(12)
    v_mfma_f32_16x16x32_bf16 v[124:127], v[176:179], v[236:239], v[124:127]
    ds_read_b64_tr_b16 v[60:61], v22 offset:0
    ds_read_b64_tr_b16 v[62:63], v22 offset:1024
    ds_read_b64_tr_b16 v[64:65], v23 offset:0
    ds_read_b64_tr_b16 v[66:67], v23 offset:1024
    v_mfma_f32_16x16x32_bf16 v[128:131], v[176:179], v[240:243], v[128:131]
    v_mfma_f32_16x16x32_bf16 v[156:159], v[176:179], v[244:247], v[156:159]
    v_mfma_f32_16x16x32_bf16 v[160:163], v[176:179], v[248:251], v[160:163]
    s_waitcnt vmcnt(4) lgkmcnt(8)
    v_mfma_f32_16x16x32_bf16 v[116:119], v[44:47], v[188:191], v[116:119]
    v_mul_f32 v72, v31, v68
    v_mul_f32 v73, v31, v69
    v_mfma_f32_16x16x32_bf16 v[120:123], v[44:47], v[192:195], v[120:123]
    v_mul_f32 v74, v31, v70
    v_mul_f32 v75, v31, v71
    v_mfma_f32_16x16x32_bf16 v[124:127], v[48:51], v[188:191], v[124:127]
    v_mul_f32 v80, v31, v76
    v_mul_f32 v81, v31, v77
    v_mfma_f32_16x16x32_bf16 v[128:131], v[48:51], v[192:195], v[128:131]
    v_mul_f32 v82, v31, v78
    v_mul_f32 v83, v31, v79
    s_waitcnt vmcnt(0) lgkmcnt(0)
    v_mfma_f32_16x16x32_bf16 v[116:119], v[60:63], v[204:207], v[116:119]
    v_mul_f32 v68, v30, v68
    v_mul_f32 v69, v30, v69
    v_mfma_f32_16x16x32_bf16 v[120:123], v[60:63], v[208:211], v[120:123]
    v_mul_f32 v70, v30, v70
    v_mul_f32 v71, v30, v71
    v_mfma_f32_16x16x32_bf16 v[124:127], v[64:67], v[204:207], v[124:127]
    v_mul_f32 v76, v30, v76
    v_mul_f32 v77, v30, v77
    v_mfma_f32_16x16x32_bf16 v[128:131], v[64:67], v[208:211], v[128:131]
    v_mul_f32 v78, v30, v78
    v_mul_f32 v79, v30, v79
    v_mfma_f32_16x16x32_bf16 v[132:135], v[36:39], v[196:199], v[132:135]
    v_mfma_f32_16x16x32_bf16 v[136:139], v[36:39], v[200:203], v[136:139]
    v_mfma_f32_16x16x32_bf16 v[140:143], v[40:43], v[196:199], v[140:143]
    ds_write_b128 v84, v[116:119] offset:16384
    v_mfma_f32_16x16x32_bf16 v[144:147], v[40:43], v[200:203], v[144:147]
    ds_write_b128 v84, v[120:123] offset:17408
    v_mfma_f32_16x16x32_bf16 v[132:135], v[52:55], v[212:215], v[132:135]
    ds_write_b128 v84, v[124:127] offset:24576
    v_mfma_f32_16x16x32_bf16 v[136:139], v[52:55], v[216:219], v[136:139]
    ds_write_b128 v84, v[128:131] offset:25600
    v_mfma_f32_16x16x32_bf16 v[140:143], v[56:59], v[212:215], v[140:143]
    v_mfma_f32_16x16x32_bf16 v[144:147], v[56:59], v[216:219], v[144:147]
    v_mfma_f32_16x16x32_bf16 v[148:151], v[44:47], v[196:199], v[148:151]
    v_mfma_f32_16x16x32_bf16 v[152:155], v[44:47], v[200:203], v[152:155]
    v_mfma_f32_16x16x32_bf16 v[156:159], v[48:51], v[196:199], v[156:159]
    ds_write_b128 v84, v[132:135] offset:32768
    v_mfma_f32_16x16x32_bf16 v[160:163], v[48:51], v[200:203], v[160:163]
    ds_write_b128 v84, v[136:139] offset:33792
    v_mfma_f32_16x16x32_bf16 v[148:151], v[60:63], v[212:215], v[148:151]
    ds_write_b128 v84, v[140:143] offset:40960
    v_mfma_f32_16x16x32_bf16 v[152:155], v[60:63], v[216:219], v[152:155]
    ds_write_b128 v84, v[144:147] offset:41984
    v_mfma_f32_16x16x32_bf16 v[156:159], v[64:67], v[212:215], v[156:159]
    v_mfma_f32_16x16x32_bf16 v[160:163], v[64:67], v[216:219], v[160:163]
    v_mfma_f32_16x16x32_bf16 v[100:103], v[36:39], v[188:191], v[100:103]
    v_mfma_f32_16x16x32_bf16 v[104:107], v[36:39], v[192:195], v[104:107]
    v_mfma_f32_16x16x32_bf16 v[108:111], v[40:43], v[188:191], v[108:111]
    ds_write_b128 v84, v[148:151] offset:49152
    v_mfma_f32_16x16x32_bf16 v[112:115], v[40:43], v[192:195], v[112:115]
    ds_write_b128 v84, v[152:155] offset:50176
    v_mfma_f32_16x16x32_bf16 v[100:103], v[52:55], v[204:207], v[100:103]
    ds_write_b128 v84, v[156:159] offset:57344
    v_mfma_f32_16x16x32_bf16 v[104:107], v[52:55], v[208:211], v[104:107]
    ds_write_b128 v84, v[160:163] offset:58368
    v_mfma_f32_16x16x32_bf16 v[108:111], v[56:59], v[204:207], v[108:111]
    v_mfma_f32_16x16x32_bf16 v[112:115], v[56:59], v[208:211], v[112:115]
    s_waitcnt lgkmcnt(0)
    s_barrier
    ds_read_b128 v[116:119], v85 offset:16384
    ds_read_b128 v[120:123], v85 offset:17408
    ds_read_b128 v[124:127], v85 offset:24576
    ds_read_b128 v[128:131], v85 offset:25600
    ds_read_b128 v[132:135], v86 offset:32768
    ds_read_b128 v[136:139], v86 offset:33792
    ds_read_b128 v[140:143], v86 offset:40960
    ds_read_b128 v[144:147], v86 offset:41984
    ds_read_b128 v[148:151], v87 offset:49152
    ds_read_b128 v[152:155], v87 offset:50176
    ds_read_b128 v[156:159], v87 offset:57344
    ds_read_b128 v[160:163], v87 offset:58368
    v_pk_add_f32 v[100:101], v[100:101], v[68:69]
    v_pk_add_f32 v[102:103], v[102:103], v[70:71]
    v_pk_add_f32 v[104:105], v[104:105], v[72:73]
    v_pk_add_f32 v[106:107], v[106:107], v[74:75]
    v_pk_add_f32 v[108:109], v[108:109], v[76:77]
    v_pk_add_f32 v[110:111], v[110:111], v[78:79]
    v_pk_add_f32 v[112:113], v[112:113], v[80:81]
    v_pk_add_f32 v[114:115], v[114:115], v[82:83]
    s_waitcnt lgkmcnt(11)
    v_pk_add_f32 v[100:101], v[100:101], v[116:117]
    v_pk_add_f32 v[102:103], v[102:103], v[118:119]
    s_waitcnt lgkmcnt(10)
    v_pk_add_f32 v[104:105], v[104:105], v[120:121]
    v_pk_add_f32 v[106:107], v[106:107], v[122:123]
    s_waitcnt lgkmcnt(9)
    v_pk_add_f32 v[108:109], v[108:109], v[124:125]
    v_pk_add_f32 v[110:111], v[110:111], v[126:127]
    s_waitcnt lgkmcnt(8)
    v_pk_add_f32 v[112:113], v[112:113], v[128:129]
    v_pk_add_f32 v[114:115], v[114:115], v[130:131]
    s_waitcnt lgkmcnt(7)
    v_pk_add_f32 v[100:101], v[100:101], v[132:133]
    v_pk_add_f32 v[102:103], v[102:103], v[134:135]
    s_waitcnt lgkmcnt(6)
    v_pk_add_f32 v[104:105], v[104:105], v[136:137]
    v_pk_add_f32 v[106:107], v[106:107], v[138:139]
    s_waitcnt lgkmcnt(5)
    v_pk_add_f32 v[108:109], v[108:109], v[140:141]
    v_pk_add_f32 v[110:111], v[110:111], v[142:143]
    s_waitcnt lgkmcnt(4)
    v_pk_add_f32 v[112:113], v[112:113], v[144:145]
    v_pk_add_f32 v[114:115], v[114:115], v[146:147]
    s_waitcnt lgkmcnt(3)
    v_pk_add_f32 v[100:101], v[100:101], v[148:149]
    v_pk_add_f32 v[102:103], v[102:103], v[150:151]
    s_waitcnt lgkmcnt(2)
    v_pk_add_f32 v[104:105], v[104:105], v[152:153]
    v_pk_add_f32 v[106:107], v[106:107], v[154:155]
    s_waitcnt lgkmcnt(1)
    v_pk_add_f32 v[108:109], v[108:109], v[156:157]
    v_pk_add_f32 v[110:111], v[110:111], v[158:159]
    s_waitcnt lgkmcnt(0)
    v_pk_add_f32 v[112:113], v[112:113], v[160:161]
    v_pk_add_f32 v[114:115], v[114:115], v[162:163]
    v_cvt_pk_bf16_f32 v36, v100, v101
    v_cvt_pk_bf16_f32 v37, v102, v103
    v_cvt_pk_bf16_f32 v38, v104, v105
    v_cvt_pk_bf16_f32 v39, v106, v107
    v_cvt_pk_bf16_f32 v40, v108, v109
    v_cvt_pk_bf16_f32 v41, v110, v111
    v_cvt_pk_bf16_f32 v42, v112, v113
    v_cvt_pk_bf16_f32 v43, v114, v115
    v_permlane16_swap_b32 v36, v38
    v_permlane16_swap_b32 v37, v39
    v_permlane16_swap_b32 v40, v42
    v_permlane16_swap_b32 v41, v43
    ds_write_b128 v89, v[36:39]
    ds_write_b128 v91, v[40:43]
    s_waitcnt lgkmcnt(0)
    s_barrier
    ds_read_b128 v[36:39], v92
    ds_read_b128 v[40:43], v92 offset:1024
    s_waitcnt lgkmcnt(1)
    buffer_store_dwordx4 v[36:39], v88, s[88:91], s64 offen
    s_waitcnt lgkmcnt(0)
    buffer_store_dwordx4 v[40:43], v88, s[88:91], s65 offen
    s_endpgm
L_streamA:
    s_mov_b64 exec, -1
    v_lshlrev_b32 v2, 4, v1
    v_mov_b32 v3, 0
    s_waitcnt lgkmcnt(0)
    s_cmp_lg_u32 s52, 6
    s_cbranch_scc1 L_15
    s_mov_b32 m0, 151552
    s_nop 0
    global_load_lds_dwordx4 v2, s[20:21]
L_15:
    s_mov_b32 s36, s26
    s_mov_b32 s37, s27
    s_mov_b32 s38, 33554432
    s_mov_b32 s39, 0x20000
    s_lshr_b32 s60, s2, 3
    s_and_b32 s59, s2, 6
    s_and_b32 s61, s60, 7
    s_lshl2_add_u32 s56, s59, s61
    s_and_b32 s59, s2, 1
    s_lshr_b32 s60, s60, 3
    s_lshl2_add_u32 s57, s59, s60
    v_lshrrev_b32 v5, 3, v1
    v_and_b32 v4, 6, v5
    v_and_b32 v6, 7, v1
    v_xor_b32 v4, v4, v6
    v_lshlrev_b32 v4, 4, v4
    s_lshl_b32 s59, s57, 7
    v_add_u32 v4, s59, v4
    v_and_b32 v6, 4, v5
    s_mul_i32 s59, s53, 448
    v_add3_u32 v6, v6, v5, s59
    v_lshl_add_u32 v10, v6, 10, v4
    v_add_u32 v11, 3072, v10
    s_lshl_b32 s98, s53, 11
    s_bfe_u32 s59, s2, 0x10001
    s_and_b32 s86, s56, 3
    s_lshl1_add_u32 s86, s86, s59
    s_mul_i32 s60, s86, 7
    s_lshr_b32 s60, s60, 2
    s_lshl_b32 s84, s60, 15
    s_lshl_b32 s85, s60, 11
    s_and_b32 s86, s86, 6
    s_mov_b32 s0, s84
    s_mov_b32 s1, s98
    s_add_u32 s59, s56, s2
    s_and_b32 s59, s59, 3
    s_lshl_b32 s60, s53, 2
    s_add_u32 s59, s59, s60
    s_lshl_b32 s61, s57, 7
    s_mul_i32 s60, s59, 114688
    s_add_u32 s96, s60, s61
    s_lshl_b32 s60, s59, 15
    s_add_u32 s97, s60, s61
    s_mov_b32 s28, s8
    s_mov_b32 s29, s9
    s_mov_b32 s30, 524288
    s_mov_b32 s31, 0x20000
    s_cmp_lg_u32 s52, 5
    s_cbranch_scc1 L_16
    v_mov_b32 v4, 0x3f803f80
    v_mov_b32 v5, 0x3f803f80
    v_lshlrev_b32 v6, 3, v1
    v_add_u32 v6, 152704, v6
    ds_write_b64 v6, v[4:5]
    ds_write_b64 v6, v[4:5] offset:512
    v_lshlrev_b32 v8, 2, v1
    v_add_u32 v8, 156416, v8
    ds_write_b32 v8, v3
    s_waitcnt lgkmcnt(0)
L_16:
    v_lshrrev_b32 v25, 4, v1
    v_and_b32 v4, 15, v1
    v_lshrrev_b32 v5, 1, v4
    v_xor_b32 v5, v5, v25
    v_lshlrev_b32 v5, 4, v5
    v_lshl_add_u32 v5, v4, 7, v5
    s_lshl_b32 s59, s53, 12
    v_add_u32 v23, s59, v5
    v_xor_b32 v24, 64, v23
    v_lshrrev_b32 v6, 2, v1
    v_and_b32 v7, 3, v1
    v_lshlrev_b32 v7, 3, v7
    s_lshl_b32 s59, s54, 12
    s_lshl_b32 s60, s55, 8
    s_add_u32 s3, s59, s60
    s_add_u32 s3, s3, 22020096
    s_add_u32 s59, s3, 0
    s_mov_b32 s100, 0
    s_atomic_add s100, s[26:27], s59 glc
    s_add_u32 s59, s3, 131072
    s_mov_b32 s101, 0
    s_atomic_add s101, s[26:27], s59 glc
    v_mul_u32_u24 v37, 96, v6
    v_add_u32 v37, v37, v7
    v_add_u32 v38, 49152, v37
    s_min_u32 s59, s53, 2
    s_lshl_b32 s59, s59, 5
    v_add_u32 v37, s59, v37
    v_add_u32 v38, s59, v38
    s_lshl_b32 s59, s59, 1
    s_add_u32 s59, s59, 156160
    v_lshlrev_b32 v39, 4, v25
    v_add_u32 v39, s59, v39
    v_lshl_add_u32 v8, v6, 7, v7
    v_and_b32 v9, 6, v6
    v_lshl_add_u32 v8, v9, 4, v8
    v_add_u32 v26, 49152, v8
    v_xor_b32 v27, 32, v26
    v_xor_b32 v28, 64, v26
    v_xor_b32 v29, 96, v26
    v_lshl_add_u32 v8, v6, 6, v7
    v_and_b32 v9, 1, v25
    v_lshl_add_u32 v8, v9, 5, v8
    v_add_u32 v30, 57344, v8
    v_xor_b32 v31, 32, v30
    v_and_b32 v4, 1, v1
    v_mul_u32_u24 v4, 1152, v4
    v_lshlrev_b32 v5, 4, v25
    v_sub_u32 v5, v5, v4
    v_add_u32 v32, 152704, v5
    v_and_b32 v4, 15, v1
    s_lshl_b32 s59, s53, 5
    v_add_u32 v5, s59, v4
    v_lshlrev_b32 v34, 4, v5
    v_add_u32 v34, 153856, v34
    s_lshl_b32 s59, s54, 9
    s_add_u32 s59, s59, 20971520
    s_lshl_b32 s60, s55, 11
    s_add_u32 s59, s59, s60
    s_and_b32 s60, s55, 3
    s_cselect_b32 s59, 33554432, s59
    v_lshlrev_b32 v35, 2, v5
    v_add_u32 v35, s59, v35
    s_lshl_b32 s60, s54, 2
    s_add_u32 s60, s60, s53
    s_lshl_b32 s59, s55, 8
    s_add_u32 s59, s59, s60
    s_lshl_b32 s40, s59, 10
    s_lshl_b32 s59, s55, 7
    s_add_u32 s59, s59, s60
    s_add_u32 s59, s59, 4096
    s_lshl_b32 s44, s59, 10
    s_add_u32 s45, s44, 65536
    s_cmp_lt_u32 s55, 8
    s_cselect_b32 s46, 1052289595, 1.0
    s_add_u32 s41, s40, 65536
    s_add_u32 s42, s40, 131072
    s_add_u32 s43, s40, 196608
    s_mov_b32 s12, 0x22222222
    s_mov_b32 s13, 0x22222222
    s_mov_b32 s14, 0x44444444
    s_mov_b32 s15, 0x44444444
    s_mov_b32 s20, 0x88888888
    s_mov_b32 s21, 0x88888888
    s_and_b32 s59, s53, 1
    s_lshl_b32 s56, s55, 1
    s_add_u32 s56, s56, s59
    s_and_b32 s59, s53, 2
    s_lshl_b32 s57, s54, 2
    s_add_u32 s57, s57, s59
    s_lshr_b32 s59, s55, 1
    s_lshl_b32 s59, s59, 8
    s_add_u32 s59, s59, 22020096
    s_sub_i32 s60, s54, 0
    s_max_i32 s60, s60, 0
    s_lshl_b32 s60, s60, 12
    s_add_u32 s4, s60, s59
    s_lshr_b32 s59, s55, 1
    s_lshl_b32 s59, s59, 8
    s_add_u32 s59, s59, 22022144
    s_sub_i32 s60, s54, 0
    s_max_i32 s60, s60, 0
    s_lshl_b32 s60, s60, 12
    s_add_u32 s5, s60, s59
    s_sub_i32 s60, s54, 1
    s_max_i32 s60, s60, 0
    s_lshl_b32 s60, s60, 12
    s_add_u32 s6, s60, s59
    s_sub_i32 s60, s54, 2
    s_max_i32 s60, s60, 0
    s_lshl_b32 s60, s60, 12
    s_add_u32 s7, s60, s59
    s_lshl_b32 s59, s55, 8
    s_add_u32 s59, s59, 22020096
    s_sub_i32 s60, s54, 0
    s_max_i32 s60, s60, 0
    s_lshl_b32 s60, s60, 12
    s_add_u32 s8, s60, s59
    s_sub_i32 s60, s54, 1
    s_max_i32 s60, s60, 0
    s_lshl_b32 s60, s60, 12
    s_add_u32 s9, s60, s59
    s_sub_i32 s60, s54, 2
    s_max_i32 s60, s60, 0
    s_lshl_b32 s60, s60, 12
    s_add_u32 s18, s60, s59
    v_and_b32 v4, 31, v1
    s_and_b32 s59, s53, 2
    s_lshl_b32 s59, s59, 9
    s_add_u32 s59, s59, 153868
    v_lshlrev_b32 v5, 4, v4
    v_add_u32 v13, s59, v5
    s_lshl_b32 s59, s53, 2
    s_add_u32 s59, s59, 156432
    v_mov_b32 v14, s59
    v_lshrrev_b32 v6, 5, v1
    v_lshlrev_b32 v7, 2, v6
    v_sub_u32 v7, v4, v7
    v_cmp_le_i32 s[64:65], 0, v7
    v_cmp_le_i32 s[66:67], 1, v7
    v_cmp_le_i32 s[68:69], 2, v7
    v_cmp_le_i32 s[70:71], 3, v7
    v_cmp_le_i32 s[72:73], 8, v7
    v_cmp_le_i32 s[74:75], 9, v7
    v_cmp_le_i32 s[76:77], 10, v7
    v_cmp_le_i32 s[78:79], 11, v7
    v_cmp_le_i32 s[80:81], 16, v7
    v_cmp_le_i32 s[82:83], 17, v7
    v_cmp_le_i32 s[84:85], 18, v7
    v_cmp_le_i32 s[86:87], 19, v7
    v_cmp_le_i32 s[88:89], 24, v7
    v_cmp_le_i32 s[90:91], 25, v7
    v_cmp_le_i32 s[92:93], 26, v7
    v_cmp_le_i32 s[94:95], 27, v7
    v_mov_b32 v8, 0xffff
    v_mov_b32 v9, 0xffff0000
    v_cndmask_b32 v15, 0, v8, s[64:65]
    v_cndmask_b32 v12, 0, v9, s[66:67]
    v_or_b32 v15, v15, v12
    v_cndmask_b32 v16, 0, v8, s[68:69]
    v_cndmask_b32 v12, 0, v9, s[70:71]
    v_or_b32 v16, v16, v12
    v_cndmask_b32 v17, 0, v8, s[72:73]
    v_cndmask_b32 v12, 0, v9, s[74:75]
    v_or_b32 v17, v17, v12
    v_cndmask_b32 v18, 0, v8, s[76:77]
    v_cndmask_b32 v12, 0, v9, s[78:79]
    v_or_b32 v18, v18, v12
    v_cndmask_b32 v19, 0, v8, s[80:81]
    v_cndmask_b32 v12, 0, v9, s[82:83]
    v_or_b32 v19, v19, v12
    v_cndmask_b32 v20, 0, v8, s[84:85]
    v_cndmask_b32 v12, 0, v9, s[86:87]
    v_or_b32 v20, v20, v12
    v_cndmask_b32 v21, 0, v8, s[88:89]
    v_cndmask_b32 v12, 0, v9, s[90:91]
    v_or_b32 v21, v21, v12
    v_cndmask_b32 v22, 0, v8, s[92:93]
    v_cndmask_b32 v12, 0, v9, s[94:95]
    v_or_b32 v22, v22, v12
    v_and_b32 v12, 15, v1
    v_lshl_add_u32 v12, v6, 4, v12
    v_and_b32 v8, 16, v1
    v_lshl_add_u32 v12, v8, 1, v12
    v_lshlrev_b32 v12, 4, v12
    s_lshl_b32 s47, s56, 6
    s_add_u32 s47, s47, s57
    s_lshl_b32 s47, s47, 10
    s_sub_i32 s98, 8, s57
    s_max_i32 s98, s98, 0
    s_cmp_gt_u32 s98, 0
    s_cselect_b32 s59, 0, 0x3f803f80
    v_mov_b32 v179, s59
    v_mov_b32 v176, v179
    v_mov_b32 v177, v179
    v_mov_b32 v178, v179
    s_cmp_gt_u32 s98, 1
    s_cselect_b32 s59, 0, 0x3f803f80
    v_mov_b32 v187, s59
    v_mov_b32 v184, v187
    v_mov_b32 v185, v187
    v_mov_b32 v186, v187
    s_cmp_gt_u32 s98, 2
    s_cselect_b32 s59, 0, 0x3f803f80
    v_mov_b32 v195, s59
    v_mov_b32 v192, v195
    v_mov_b32 v193, v195
    v_mov_b32 v194, v195
    s_cmp_gt_u32 s98, 3
    s_cselect_b32 s59, 0, 0x3f803f80
    v_mov_b32 v203, s59
    v_mov_b32 v200, v203
    v_mov_b32 v201, v203
    v_mov_b32 v202, v203
    s_cmp_gt_u32 s98, 4
    s_cselect_b32 s59, 0, 0x3f803f80
    v_mov_b32 v211, s59
    v_mov_b32 v208, v211
    v_mov_b32 v209, v211
    v_mov_b32 v210, v211
    s_cmp_gt_u32 s98, 5
    s_cselect_b32 s59, 0, 0x3f803f80
    v_mov_b32 v219, s59
    v_mov_b32 v216, v219
    v_mov_b32 v217, v219
    v_mov_b32 v218, v219
    s_cmp_gt_u32 s98, 6
    s_cselect_b32 s59, 0, 0x3f803f80
    v_mov_b32 v227, s59
    v_mov_b32 v224, v227
    v_mov_b32 v225, v227
    v_mov_b32 v226, v227
    s_cmp_gt_u32 s98, 7
    s_cselect_b32 s59, 0, 0x3f803f80
    v_mov_b32 v235, s59
    v_mov_b32 v232, v235
    v_mov_b32 v233, v235
    v_mov_b32 v234, v235
    s_cmp_gt_u32 s98, 8
    s_cselect_b32 s59, 0, 0x3f803f80
    v_mov_b32 v243, s59
    v_mov_b32 v240, v243
    v_mov_b32 v241, v243
    v_mov_b32 v242, v243
    s_cmp_gt_u32 s98, 9
    s_cselect_b32 s59, 0, 0x3f803f80
    v_mov_b32 v251, s59
    v_mov_b32 v248, v251
    v_mov_b32 v249, v251
    v_mov_b32 v250, v251
    s_setprio 1
    s_waitcnt vmcnt(0) lgkmcnt(0)
    s_barrier
    ds_read_b128 v[104:107], v23 offset:0
    ds_read_b128 v[108:111], v23 offset:2048
    s_add_u32 s51, s50, 0
    s_and_b32 s51, s51, 1023
    v_add_u32 v33, s51, v32
    ds_read_b128 v[168:171], v33 offset:0
    ds_read_b64_tr_b16 v[120:121], v26 offset:0
    ds_read_b64_tr_b16 v[122:123], v26 offset:2048
    ds_read_b64_tr_b16 v[124:125], v27 offset:0
    ds_read_b64_tr_b16 v[126:127], v27 offset:2048
    ds_read_b64_tr_b16 v[128:129], v28 offset:0
    ds_read_b64_tr_b16 v[130:131], v28 offset:2048
    ds_read_b64_tr_b16 v[132:133], v29 offset:0
    ds_read_b64_tr_b16 v[134:135], v29 offset:2048
    ds_read_b64_tr_b16 v[136:137], v30 offset:0
    ds_read_b64_tr_b16 v[138:139], v30 offset:1024
    ds_read_b64_tr_b16 v[140:141], v31 offset:0
    ds_read_b64_tr_b16 v[142:143], v31 offset:1024
    s_waitcnt lgkmcnt(14)
    v_mfma_f32_16x16x32_bf16 v[88:91], v[104:107], v[104:107], 0
    ds_read_b128 v[112:115], v24 offset:0
    ds_read_b128 v[116:119], v24 offset:2048
    s_waitcnt lgkmcnt(15)
    v_mfma_f32_16x16x32_bf16 v[92:95], v[108:111], v[108:111], 0
    ds_read_b128 v[172:175], v33 offset:64
    ds_read_b64_tr_b16 v[144:145], v26 offset:4096
    s_waitcnt lgkmcnt(15)
    v_mfma_f32_16x16x32_bf16 v[96:99], v[168:171], v[104:107], 0
    ds_read_b64_tr_b16 v[146:147], v26 offset:6144
    v_mfma_f32_16x16x32_bf16 v[100:103], v[168:171], v[108:111], 0
    ds_read_b64_tr_b16 v[148:149], v27 offset:4096
    s_waitcnt lgkmcnt(15)
    v_mfma_f32_16x16x32_bf16 v[40:43], v[120:123], v[104:107], 0
    ds_read_b64_tr_b16 v[150:151], v27 offset:6144
    v_mfma_f32_16x16x32_bf16 v[44:47], v[120:123], v[108:111], 0
    ds_read_b64_tr_b16 v[152:153], v28 offset:4096
    s_waitcnt lgkmcnt(15)
    v_mfma_f32_16x16x32_bf16 v[48:51], v[124:127], v[104:107], 0
    ds_read_b64_tr_b16 v[154:155], v28 offset:6144
    v_mfma_f32_16x16x32_bf16 v[52:55], v[124:127], v[108:111], 0
    ds_read_b64_tr_b16 v[156:157], v29 offset:4096
    s_waitcnt lgkmcnt(15)
    v_mfma_f32_16x16x32_bf16 v[56:59], v[128:131], v[104:107], 0
    ds_read_b64_tr_b16 v[158:159], v29 offset:6144
    v_mfma_f32_16x16x32_bf16 v[60:63], v[128:131], v[108:111], 0
    ds_read_b64_tr_b16 v[160:161], v30 offset:2048
    s_waitcnt lgkmcnt(15)
    v_mfma_f32_16x16x32_bf16 v[64:67], v[132:135], v[104:107], 0
    ds_read_b64_tr_b16 v[162:163], v30 offset:3072
    v_mfma_f32_16x16x32_bf16 v[68:71], v[132:135], v[108:111], 0
    ds_read_b64_tr_b16 v[164:165], v31 offset:2048
    s_waitcnt lgkmcnt(15)
    v_mfma_f32_16x16x32_bf16 v[72:75], v[104:107], v[136:139], 0
    ds_read_b64_tr_b16 v[166:167], v31 offset:3072
    v_mfma_f32_16x16x32_bf16 v[76:79], v[108:111], v[136:139], 0
    s_waitcnt lgkmcnt(15)
    v_mfma_f32_16x16x32_bf16 v[80:83], v[104:107], v[140:143], 0
    v_mfma_f32_16x16x32_bf16 v[84:87], v[108:111], v[140:143], 0
    s_waitcnt lgkmcnt(0)
    s_barrier
    v_mfma_f32_16x16x32_bf16 v[88:91], v[112:115], v[112:115], v[88:91]
    ds_read_b128 v[104:107], v23 offset:16384
    ds_read_b128 v[108:111], v23 offset:18432
    v_mfma_f32_16x16x32_bf16 v[92:95], v[116:119], v[116:119], v[92:95]
    s_add_u32 s51, s50, 128
    s_and_b32 s51, s51, 1023
    v_add_u32 v33, s51, v32
    ds_read_b128 v[168:171], v33 offset:0
    ds_read_b64_tr_b16 v[120:121], v26 offset:12288
    v_mfma_f32_16x16x32_bf16 v[96:99], v[172:175], v[112:115], v[96:99]
    ds_read_b64_tr_b16 v[122:123], v26 offset:14336
    v_mfma_f32_16x16x32_bf16 v[100:103], v[172:175], v[116:119], v[100:103]
    ds_read_b64_tr_b16 v[124:125], v27 offset:12288
    v_mfma_f32_16x16x32_bf16 v[40:43], v[144:147], v[112:115], v[40:43]
    ds_read_b64_tr_b16 v[126:127], v27 offset:14336
    v_mfma_f32_16x16x32_bf16 v[44:47], v[144:147], v[116:119], v[44:47]
    ds_read_b64_tr_b16 v[128:129], v28 offset:12288
    v_mfma_f32_16x16x32_bf16 v[48:51], v[148:151], v[112:115], v[48:51]
    ds_read_b64_tr_b16 v[130:131], v28 offset:14336
    v_mfma_f32_16x16x32_bf16 v[52:55], v[148:151], v[116:119], v[52:55]
    ds_read_b64_tr_b16 v[132:133], v29 offset:12288
    v_mfma_f32_16x16x32_bf16 v[56:59], v[152:155], v[112:115], v[56:59]
    ds_read_b64_tr_b16 v[134:135], v29 offset:14336
    v_mfma_f32_16x16x32_bf16 v[60:63], v[152:155], v[116:119], v[60:63]
    ds_read_b64_tr_b16 v[136:137], v30 offset:12288
    v_mfma_f32_16x16x32_bf16 v[64:67], v[156:159], v[112:115], v[64:67]
    ds_read_b64_tr_b16 v[138:139], v30 offset:13312
    v_mfma_f32_16x16x32_bf16 v[68:71], v[156:159], v[116:119], v[68:71]
    ds_read_b64_tr_b16 v[140:141], v31 offset:12288
    v_mfma_f32_16x16x32_bf16 v[72:75], v[112:115], v[160:163], v[72:75]
    ds_read_b64_tr_b16 v[142:143], v31 offset:13312
    v_mfma_f32_16x16x32_bf16 v[76:79], v[116:119], v[160:163], v[76:79]
    v_mfma_f32_16x16x32_bf16 v[80:83], v[112:115], v[164:167], v[80:83]
    v_mfma_f32_16x16x32_bf16 v[84:87], v[116:119], v[164:167], v[84:87]
    s_waitcnt lgkmcnt(0)
    v_mfma_f32_16x16x32_bf16 v[88:91], v[104:107], v[104:107], v[88:91]
    ds_read_b128 v[112:115], v24 offset:16384
    ds_read_b128 v[116:119], v24 offset:18432
    v_mfma_f32_16x16x32_bf16 v[92:95], v[108:111], v[108:111], v[92:95]
    ds_read_b128 v[172:175], v33 offset:64
    ds_read_b64_tr_b16 v[144:145], v26 offset:16384
    v_mfma_f32_16x16x32_bf16 v[96:99], v[168:171], v[104:107], v[96:99]
    ds_read_b64_tr_b16 v[146:147], v26 offset:18432
    v_mfma_f32_16x16x32_bf16 v[100:103], v[168:171], v[108:111], v[100:103]
    ds_read_b64_tr_b16 v[148:149], v27 offset:16384
    v_mfma_f32_16x16x32_bf16 v[40:43], v[120:123], v[104:107], v[40:43]
    ds_read_b64_tr_b16 v[150:151], v27 offset:18432
    v_mfma_f32_16x16x32_bf16 v[44:47], v[120:123], v[108:111], v[44:47]
    ds_read_b64_tr_b16 v[152:153], v28 offset:16384
    v_mfma_f32_16x16x32_bf16 v[48:51], v[124:127], v[104:107], v[48:51]
    ds_read_b64_tr_b16 v[154:155], v28 offset:18432
    v_mfma_f32_16x16x32_bf16 v[52:55], v[124:127], v[108:111], v[52:55]
    ds_read_b64_tr_b16 v[156:157], v29 offset:16384
    v_mfma_f32_16x16x32_bf16 v[56:59], v[128:131], v[104:107], v[56:59]
    ds_read_b64_tr_b16 v[158:159], v29 offset:18432
    v_mfma_f32_16x16x32_bf16 v[60:63], v[128:131], v[108:111], v[60:63]
    ds_read_b64_tr_b16 v[160:161], v30 offset:14336
    v_mfma_f32_16x16x32_bf16 v[64:67], v[132:135], v[104:107], v[64:67]
    ds_read_b64_tr_b16 v[162:163], v30 offset:15360
    v_mfma_f32_16x16x32_bf16 v[68:71], v[132:135], v[108:111], v[68:71]
    ds_read_b64_tr_b16 v[164:165], v31 offset:14336
    v_mfma_f32_16x16x32_bf16 v[72:75], v[104:107], v[136:139], v[72:75]
    ds_read_b64_tr_b16 v[166:167], v31 offset:15360
    v_mfma_f32_16x16x32_bf16 v[76:79], v[108:111], v[136:139], v[76:79]
    v_mfma_f32_16x16x32_bf16 v[80:83], v[104:107], v[140:143], v[80:83]
    v_mfma_f32_16x16x32_bf16 v[84:87], v[108:111], v[140:143], v[84:87]
    s_waitcnt lgkmcnt(0)
    s_barrier
    v_mfma_f32_16x16x32_bf16 v[88:91], v[112:115], v[112:115], v[88:91]
    ds_read_b128 v[104:107], v23 offset:32768
    ds_read_b128 v[108:111], v23 offset:34816
    v_mfma_f32_16x16x32_bf16 v[92:95], v[116:119], v[116:119], v[92:95]
    s_add_u32 s51, s50, 256
    s_and_b32 s51, s51, 1023
    v_add_u32 v33, s51, v32
    ds_read_b128 v[168:171], v33 offset:0
    ds_read_b64_tr_b16 v[120:121], v26 offset:24576
    v_mfma_f32_16x16x32_bf16 v[96:99], v[172:175], v[112:115], v[96:99]
    ds_read_b64_tr_b16 v[122:123], v26 offset:26624
    v_mfma_f32_16x16x32_bf16 v[100:103], v[172:175], v[116:119], v[100:103]
    ds_read_b64_tr_b16 v[124:125], v27 offset:24576
    v_mfma_f32_16x16x32_bf16 v[40:43], v[144:147], v[112:115], v[40:43]
    ds_read_b64_tr_b16 v[126:127], v27 offset:26624
    v_mfma_f32_16x16x32_bf16 v[44:47], v[144:147], v[116:119], v[44:47]
    ds_read_b64_tr_b16 v[128:129], v28 offset:24576
    v_mfma_f32_16x16x32_bf16 v[48:51], v[148:151], v[112:115], v[48:51]
    ds_read_b64_tr_b16 v[130:131], v28 offset:26624
    v_mfma_f32_16x16x32_bf16 v[52:55], v[148:151], v[116:119], v[52:55]
    ds_read_b64_tr_b16 v[132:133], v29 offset:24576
    v_mfma_f32_16x16x32_bf16 v[56:59], v[152:155], v[112:115], v[56:59]
    ds_read_b64_tr_b16 v[134:135], v29 offset:26624
    v_mfma_f32_16x16x32_bf16 v[60:63], v[152:155], v[116:119], v[60:63]
    ds_read_b64_tr_b16 v[136:137], v30 offset:24576
    v_mfma_f32_16x16x32_bf16 v[64:67], v[156:159], v[112:115], v[64:67]
    ds_read_b64_tr_b16 v[138:139], v30 offset:25600
    v_mfma_f32_16x16x32_bf16 v[68:71], v[156:159], v[116:119], v[68:71]
    ds_read_b64_tr_b16 v[140:141], v31 offset:24576
    v_mfma_f32_16x16x32_bf16 v[72:75], v[112:115], v[160:163], v[72:75]
    ds_read_b64_tr_b16 v[142:143], v31 offset:25600
    v_mfma_f32_16x16x32_bf16 v[76:79], v[116:119], v[160:163], v[76:79]
    v_mfma_f32_16x16x32_bf16 v[80:83], v[112:115], v[164:167], v[80:83]
    v_mfma_f32_16x16x32_bf16 v[84:87], v[116:119], v[164:167], v[84:87]
    s_waitcnt lgkmcnt(0)
    v_mfma_f32_16x16x32_bf16 v[88:91], v[104:107], v[104:107], v[88:91]
    ds_read_b128 v[112:115], v24 offset:32768
    ds_read_b128 v[116:119], v24 offset:34816
    v_mfma_f32_16x16x32_bf16 v[92:95], v[108:111], v[108:111], v[92:95]
    ds_read_b128 v[172:175], v33 offset:64
    ds_read_b64_tr_b16 v[144:145], v26 offset:28672
    v_mfma_f32_16x16x32_bf16 v[96:99], v[168:171], v[104:107], v[96:99]
    ds_read_b64_tr_b16 v[146:147], v26 offset:30720
    v_mfma_f32_16x16x32_bf16 v[100:103], v[168:171], v[108:111], v[100:103]
    ds_read_b64_tr_b16 v[148:149], v27 offset:28672
    v_mfma_f32_16x16x32_bf16 v[40:43], v[120:123], v[104:107], v[40:43]
    ds_read_b64_tr_b16 v[150:151], v27 offset:30720
    v_mfma_f32_16x16x32_bf16 v[44:47], v[120:123], v[108:111], v[44:47]
    ds_read_b64_tr_b16 v[152:153], v28 offset:28672
    v_mfma_f32_16x16x32_bf16 v[48:51], v[124:127], v[104:107], v[48:51]
    ds_read_b64_tr_b16 v[154:155], v28 offset:30720
    v_mfma_f32_16x16x32_bf16 v[52:55], v[124:127], v[108:111], v[52:55]
    ds_read_b64_tr_b16 v[156:157], v29 offset:28672
    v_mfma_f32_16x16x32_bf16 v[56:59], v[128:131], v[104:107], v[56:59]
    ds_read_b64_tr_b16 v[158:159], v29 offset:30720
    v_mfma_f32_16x16x32_bf16 v[60:63], v[128:131], v[108:111], v[60:63]
    ds_read_b64_tr_b16 v[160:161], v30 offset:26624
    v_mfma_f32_16x16x32_bf16 v[64:67], v[132:135], v[104:107], v[64:67]
    ds_read_b64_tr_b16 v[162:163], v30 offset:27648
    v_mfma_f32_16x16x32_bf16 v[68:71], v[132:135], v[108:111], v[68:71]
    ds_read_b64_tr_b16 v[164:165], v31 offset:26624
    v_mfma_f32_16x16x32_bf16 v[72:75], v[104:107], v[136:139], v[72:75]
    ds_read_b64_tr_b16 v[166:167], v31 offset:27648
    v_mfma_f32_16x16x32_bf16 v[76:79], v[108:111], v[136:139], v[76:79]
    v_mfma_f32_16x16x32_bf16 v[80:83], v[104:107], v[140:143], v[80:83]
    v_mfma_f32_16x16x32_bf16 v[84:87], v[108:111], v[140:143], v[84:87]
    s_waitcnt lgkmcnt(0)
    s_barrier
    v_mfma_f32_16x16x32_bf16 v[88:91], v[112:115], v[112:115], v[88:91]
    ds_read_b128 v[104:107], v23 offset:0
    ds_read_b128 v[108:111], v23 offset:2048
    v_mfma_f32_16x16x32_bf16 v[92:95], v[116:119], v[116:119], v[92:95]
    s_add_u32 s51, s50, 384
    s_and_b32 s51, s51, 1023
    v_add_u32 v33, s51, v32
    ds_read_b128 v[168:171], v33 offset:0
    ds_read_b64_tr_b16 v[120:121], v26 offset:0
    v_mfma_f32_16x16x32_bf16 v[96:99], v[172:175], v[112:115], v[96:99]
    ds_read_b64_tr_b16 v[122:123], v26 offset:2048
    v_mfma_f32_16x16x32_bf16 v[100:103], v[172:175], v[116:119], v[100:103]
    ds_read_b64_tr_b16 v[124:125], v27 offset:0
    v_mfma_f32_16x16x32_bf16 v[40:43], v[144:147], v[112:115], v[40:43]
    ds_read_b64_tr_b16 v[126:127], v27 offset:2048
    v_mfma_f32_16x16x32_bf16 v[44:47], v[144:147], v[116:119], v[44:47]
    ds_read_b64_tr_b16 v[128:129], v28 offset:0
    v_mfma_f32_16x16x32_bf16 v[48:51], v[148:151], v[112:115], v[48:51]
    ds_read_b64_tr_b16 v[130:131], v28 offset:2048
    v_mfma_f32_16x16x32_bf16 v[52:55], v[148:151], v[116:119], v[52:55]
    ds_read_b64_tr_b16 v[132:133], v29 offset:0
    v_mfma_f32_16x16x32_bf16 v[56:59], v[152:155], v[112:115], v[56:59]
    ds_read_b64_tr_b16 v[134:135], v29 offset:2048
    v_mfma_f32_16x16x32_bf16 v[60:63], v[152:155], v[116:119], v[60:63]
    ds_read_b64_tr_b16 v[136:137], v30 offset:0
    v_mfma_f32_16x16x32_bf16 v[64:67], v[156:159], v[112:115], v[64:67]
    ds_read_b64_tr_b16 v[138:139], v30 offset:1024
    v_mfma_f32_16x16x32_bf16 v[68:71], v[156:159], v[116:119], v[68:71]
    ds_read_b64_tr_b16 v[140:141], v31 offset:0
    v_mfma_f32_16x16x32_bf16 v[72:75], v[112:115], v[160:163], v[72:75]
    ds_read_b64_tr_b16 v[142:143], v31 offset:1024
    v_mfma_f32_16x16x32_bf16 v[76:79], v[116:119], v[160:163], v[76:79]
    v_mfma_f32_16x16x32_bf16 v[80:83], v[112:115], v[164:167], v[80:83]
    v_mfma_f32_16x16x32_bf16 v[84:87], v[116:119], v[164:167], v[84:87]
    s_waitcnt lgkmcnt(0)
    v_mfma_f32_16x16x32_bf16 v[88:91], v[104:107], v[104:107], v[88:91]
    ds_read_b128 v[112:115], v24 offset:0
    ds_read_b128 v[116:119], v24 offset:2048
    v_mfma_f32_16x16x32_bf16 v[92:95], v[108:111], v[108:111], v[92:95]
    ds_read_b128 v[172:175], v33 offset:64
    ds_read_b64_tr_b16 v[144:145], v26 offset:4096
    v_mfma_f32_16x16x32_bf16 v[96:99], v[168:171], v[104:107], v[96:99]
    ds_read_b64_tr_b16 v[146:147], v26 offset:6144
    v_mfma_f32_16x16x32_bf16 v[100:103], v[168:171], v[108:111], v[100:103]
    ds_read_b64_tr_b16 v[148:149], v27 offset:4096
    v_mfma_f32_16x16x32_bf16 v[40:43], v[120:123], v[104:107], v[40:43]
    ds_read_b64_tr_b16 v[150:151], v27 offset:6144
    v_mfma_f32_16x16x32_bf16 v[44:47], v[120:123], v[108:111], v[44:47]
    ds_read_b64_tr_b16 v[152:153], v28 offset:4096
    v_mfma_f32_16x16x32_bf16 v[48:51], v[124:127], v[104:107], v[48:51]
    ds_read_b64_tr_b16 v[154:155], v28 offset:6144
    v_mfma_f32_16x16x32_bf16 v[52:55], v[124:127], v[108:111], v[52:55]
    ds_read_b64_tr_b16 v[156:157], v29 offset:4096
    v_mfma_f32_16x16x32_bf16 v[56:59], v[128:131], v[104:107], v[56:59]
    ds_read_b64_tr_b16 v[158:159], v29 offset:6144
    v_mfma_f32_16x16x32_bf16 v[60:63], v[128:131], v[108:111], v[60:63]
    ds_read_b64_tr_b16 v[160:161], v30 offset:2048
    v_mfma_f32_16x16x32_bf16 v[64:67], v[132:135], v[104:107], v[64:67]
    ds_read_b64_tr_b16 v[162:163], v30 offset:3072
    v_mfma_f32_16x16x32_bf16 v[68:71], v[132:135], v[108:111], v[68:71]
    ds_read_b64_tr_b16 v[164:165], v31 offset:2048
    v_mfma_f32_16x16x32_bf16 v[72:75], v[104:107], v[136:139], v[72:75]
    ds_read_b64_tr_b16 v[166:167], v31 offset:3072
    v_mfma_f32_16x16x32_bf16 v[76:79], v[108:111], v[136:139], v[76:79]
    v_mfma_f32_16x16x32_bf16 v[80:83], v[104:107], v[140:143], v[80:83]
    v_mfma_f32_16x16x32_bf16 v[84:87], v[108:111], v[140:143], v[84:87]
    s_waitcnt lgkmcnt(0)
    s_barrier
    v_mfma_f32_16x16x32_bf16 v[88:91], v[112:115], v[112:115], v[88:91]
    ds_read_b128 v[104:107], v23 offset:16384
    ds_read_b128 v[108:111], v23 offset:18432
    v_mfma_f32_16x16x32_bf16 v[92:95], v[116:119], v[116:119], v[92:95]
    s_add_u32 s51, s50, 512
    s_and_b32 s51, s51, 1023
    v_add_u32 v33, s51, v32
    ds_read_b128 v[168:171], v33 offset:0
    ds_read_b64_tr_b16 v[120:121], v26 offset:12288
    v_mfma_f32_16x16x32_bf16 v[96:99], v[172:175], v[112:115], v[96:99]
    ds_read_b64_tr_b16 v[122:123], v26 offset:14336
    v_mfma_f32_16x16x32_bf16 v[100:103], v[172:175], v[116:119], v[100:103]
    ds_read_b64_tr_b16 v[124:125], v27 offset:12288
    v_mfma_f32_16x16x32_bf16 v[40:43], v[144:147], v[112:115], v[40:43]
    ds_read_b64_tr_b16 v[126:127], v27 offset:14336
    v_mfma_f32_16x16x32_bf16 v[44:47], v[144:147], v[116:119], v[44:47]
    ds_read_b64_tr_b16 v[128:129], v28 offset:12288
    v_mfma_f32_16x16x32_bf16 v[48:51], v[148:151], v[112:115], v[48:51]
    ds_read_b64_tr_b16 v[130:131], v28 offset:14336
    v_mfma_f32_16x16x32_bf16 v[52:55], v[148:151], v[116:119], v[52:55]
    ds_read_b64_tr_b16 v[132:133], v29 offset:12288
    v_mfma_f32_16x16x32_bf16 v[56:59], v[152:155], v[112:115], v[56:59]
    ds_read_b64_tr_b16 v[134:135], v29 offset:14336
    v_mfma_f32_16x16x32_bf16 v[60:63], v[152:155], v[116:119], v[60:63]
    ds_read_b64_tr_b16 v[136:137], v30 offset:12288
    v_mfma_f32_16x16x32_bf16 v[64:67], v[156:159], v[112:115], v[64:67]
    ds_read_b64_tr_b16 v[138:139], v30 offset:13312
    v_mfma_f32_16x16x32_bf16 v[68:71], v[156:159], v[116:119], v[68:71]
    ds_read_b64_tr_b16 v[140:141], v31 offset:12288
    v_mfma_f32_16x16x32_bf16 v[72:75], v[112:115], v[160:163], v[72:75]
    ds_read_b64_tr_b16 v[142:143], v31 offset:13312
    v_mfma_f32_16x16x32_bf16 v[76:79], v[116:119], v[160:163], v[76:79]
    v_mfma_f32_16x16x32_bf16 v[80:83], v[112:115], v[164:167], v[80:83]
    v_mfma_f32_16x16x32_bf16 v[84:87], v[116:119], v[164:167], v[84:87]
    s_waitcnt lgkmcnt(0)
    v_mfma_f32_16x16x32_bf16 v[88:91], v[104:107], v[104:107], v[88:91]
    ds_read_b128 v[112:115], v24 offset:16384
    ds_read_b128 v[116:119], v24 offset:18432
    v_mfma_f32_16x16x32_bf16 v[92:95], v[108:111], v[108:111], v[92:95]
    ds_read_b128 v[172:175], v33 offset:64
    ds_read_b64_tr_b16 v[144:145], v26 offset:16384
    v_mfma_f32_16x16x32_bf16 v[96:99], v[168:171], v[104:107], v[96:99]
    ds_read_b64_tr_b16 v[146:147], v26 offset:18432
    v_mfma_f32_16x16x32_bf16 v[100:103], v[168:171], v[108:111], v[100:103]
    ds_read_b64_tr_b16 v[148:149], v27 offset:16384
    v_mfma_f32_16x16x32_bf16 v[40:43], v[120:123], v[104:107], v[40:43]
    ds_read_b64_tr_b16 v[150:151], v27 offset:18432
    v_mfma_f32_16x16x32_bf16 v[44:47], v[120:123], v[108:111], v[44:47]
    ds_read_b64_tr_b16 v[152:153], v28 offset:16384
    v_mfma_f32_16x16x32_bf16 v[48:51], v[124:127], v[104:107], v[48:51]
    ds_read_b64_tr_b16 v[154:155], v28 offset:18432
    v_mfma_f32_16x16x32_bf16 v[52:55], v[124:127], v[108:111], v[52:55]
    ds_read_b64_tr_b16 v[156:157], v29 offset:16384
    v_mfma_f32_16x16x32_bf16 v[56:59], v[128:131], v[104:107], v[56:59]
    ds_read_b64_tr_b16 v[158:159], v29 offset:18432
    v_mfma_f32_16x16x32_bf16 v[60:63], v[128:131], v[108:111], v[60:63]
    ds_read_b64_tr_b16 v[160:161], v30 offset:14336
    v_mfma_f32_16x16x32_bf16 v[64:67], v[132:135], v[104:107], v[64:67]
    ds_read_b64_tr_b16 v[162:163], v30 offset:15360
    v_mfma_f32_16x16x32_bf16 v[68:71], v[132:135], v[108:111], v[68:71]
    ds_read_b64_tr_b16 v[164:165], v31 offset:14336
    v_mfma_f32_16x16x32_bf16 v[72:75], v[104:107], v[136:139], v[72:75]
    ds_read_b64_tr_b16 v[166:167], v31 offset:15360
    v_mfma_f32_16x16x32_bf16 v[76:79], v[108:111], v[136:139], v[76:79]
    v_mfma_f32_16x16x32_bf16 v[80:83], v[104:107], v[140:143], v[80:83]
    v_mfma_f32_16x16x32_bf16 v[84:87], v[108:111], v[140:143], v[84:87]
    s_waitcnt lgkmcnt(0)
    s_barrier
    v_mfma_f32_16x16x32_bf16 v[88:91], v[112:115], v[112:115], v[88:91]
    ds_read_b128 v[104:107], v23 offset:32768
    ds_read_b128 v[108:111], v23 offset:34816
    v_mfma_f32_16x16x32_bf16 v[92:95], v[116:119], v[116:119], v[92:95]
    s_add_u32 s51, s50, 640
    s_and_b32 s51, s51, 1023
    v_add_u32 v33, s51, v32
    ds_read_b128 v[168:171], v33 offset:0
    ds_read_b64_tr_b16 v[120:121], v26 offset:24576
    v_mfma_f32_16x16x32_bf16 v[96:99], v[172:175], v[112:115], v[96:99]
    ds_read_b64_tr_b16 v[122:123], v26 offset:26624
    v_mfma_f32_16x16x32_bf16 v[100:103], v[172:175], v[116:119], v[100:103]
    ds_read_b64_tr_b16 v[124:125], v27 offset:24576
    v_mfma_f32_16x16x32_bf16 v[40:43], v[144:147], v[112:115], v[40:43]
    ds_read_b64_tr_b16 v[126:127], v27 offset:26624
    v_mfma_f32_16x16x32_bf16 v[44:47], v[144:147], v[116:119], v[44:47]
    ds_read_b64_tr_b16 v[128:129], v28 offset:24576
    v_mfma_f32_16x16x32_bf16 v[48:51], v[148:151], v[112:115], v[48:51]
    ds_read_b64_tr_b16 v[130:131], v28 offset:26624
    v_mfma_f32_16x16x32_bf16 v[52:55], v[148:151], v[116:119], v[52:55]
    ds_read_b64_tr_b16 v[132:133], v29 offset:24576
    v_mfma_f32_16x16x32_bf16 v[56:59], v[152:155], v[112:115], v[56:59]
    ds_read_b64_tr_b16 v[134:135], v29 offset:26624
    v_mfma_f32_16x16x32_bf16 v[60:63], v[152:155], v[116:119], v[60:63]
    ds_read_b64_tr_b16 v[136:137], v30 offset:24576
    v_mfma_f32_16x16x32_bf16 v[64:67], v[156:159], v[112:115], v[64:67]
    ds_read_b64_tr_b16 v[138:139], v30 offset:25600
    v_mfma_f32_16x16x32_bf16 v[68:71], v[156:159], v[116:119], v[68:71]
    ds_read_b64_tr_b16 v[140:141], v31 offset:24576
    v_mfma_f32_16x16x32_bf16 v[72:75], v[112:115], v[160:163], v[72:75]
    ds_read_b64_tr_b16 v[142:143], v31 offset:25600
    v_mfma_f32_16x16x32_bf16 v[76:79], v[116:119], v[160:163], v[76:79]
    v_mfma_f32_16x16x32_bf16 v[80:83], v[112:115], v[164:167], v[80:83]
    v_mfma_f32_16x16x32_bf16 v[84:87], v[116:119], v[164:167], v[84:87]
    s_waitcnt lgkmcnt(0)
    v_mfma_f32_16x16x32_bf16 v[88:91], v[104:107], v[104:107], v[88:91]
    ds_read_b128 v[112:115], v24 offset:32768
    ds_read_b128 v[116:119], v24 offset:34816
    v_mfma_f32_16x16x32_bf16 v[92:95], v[108:111], v[108:111], v[92:95]
    ds_read_b128 v[172:175], v33 offset:64
    ds_read_b64_tr_b16 v[144:145], v26 offset:28672
    v_mfma_f32_16x16x32_bf16 v[96:99], v[168:171], v[104:107], v[96:99]
    ds_read_b64_tr_b16 v[146:147], v26 offset:30720
    v_mfma_f32_16x16x32_bf16 v[100:103], v[168:171], v[108:111], v[100:103]
    ds_read_b64_tr_b16 v[148:149], v27 offset:28672
    v_mfma_f32_16x16x32_bf16 v[40:43], v[120:123], v[104:107], v[40:43]
    ds_read_b64_tr_b16 v[150:151], v27 offset:30720
    v_mfma_f32_16x16x32_bf16 v[44:47], v[120:123], v[108:111], v[44:47]
    ds_read_b64_tr_b16 v[152:153], v28 offset:28672
    v_mfma_f32_16x16x32_bf16 v[48:51], v[124:127], v[104:107], v[48:51]
    ds_read_b64_tr_b16 v[154:155], v28 offset:30720
    v_mfma_f32_16x16x32_bf16 v[52:55], v[124:127], v[108:111], v[52:55]
    ds_read_b64_tr_b16 v[156:157], v29 offset:28672
    v_mfma_f32_16x16x32_bf16 v[56:59], v[128:131], v[104:107], v[56:59]
    ds_read_b64_tr_b16 v[158:159], v29 offset:30720
    v_mfma_f32_16x16x32_bf16 v[60:63], v[128:131], v[108:111], v[60:63]
    ds_read_b64_tr_b16 v[160:161], v30 offset:26624
    v_mfma_f32_16x16x32_bf16 v[64:67], v[132:135], v[104:107], v[64:67]
    ds_read_b64_tr_b16 v[162:163], v30 offset:27648
    v_mfma_f32_16x16x32_bf16 v[68:71], v[132:135], v[108:111], v[68:71]
    ds_read_b64_tr_b16 v[164:165], v31 offset:26624
    v_mfma_f32_16x16x32_bf16 v[72:75], v[104:107], v[136:139], v[72:75]
    ds_read_b64_tr_b16 v[166:167], v31 offset:27648
    v_mfma_f32_16x16x32_bf16 v[76:79], v[108:111], v[136:139], v[76:79]
    v_mfma_f32_16x16x32_bf16 v[80:83], v[104:107], v[140:143], v[80:83]
    v_mfma_f32_16x16x32_bf16 v[84:87], v[108:111], v[140:143], v[84:87]
    s_waitcnt lgkmcnt(0)
    s_barrier
    v_mfma_f32_16x16x32_bf16 v[88:91], v[112:115], v[112:115], v[88:91]
    ds_read_b128 v[104:107], v23 offset:0
    ds_read_b128 v[108:111], v23 offset:2048
    v_mfma_f32_16x16x32_bf16 v[92:95], v[116:119], v[116:119], v[92:95]
    s_add_u32 s51, s50, 768
    s_and_b32 s51, s51, 1023
    v_add_u32 v33, s51, v32
    ds_read_b128 v[168:171], v33 offset:0
    ds_read_b64_tr_b16 v[120:121], v26 offset:0
    v_mfma_f32_16x16x32_bf16 v[96:99], v[172:175], v[112:115], v[96:99]
    ds_read_b64_tr_b16 v[122:123], v26 offset:2048
    v_mfma_f32_16x16x32_bf16 v[100:103], v[172:175], v[116:119], v[100:103]
    ds_read_b64_tr_b16 v[124:125], v27 offset:0
    v_mfma_f32_16x16x32_bf16 v[40:43], v[144:147], v[112:115], v[40:43]
    ds_read_b64_tr_b16 v[126:127], v27 offset:2048
    v_mfma_f32_16x16x32_bf16 v[44:47], v[144:147], v[116:119], v[44:47]
    ds_read_b64_tr_b16 v[128:129], v28 offset:0
    v_mfma_f32_16x16x32_bf16 v[48:51], v[148:151], v[112:115], v[48:51]
    ds_read_b64_tr_b16 v[130:131], v28 offset:2048
    v_mfma_f32_16x16x32_bf16 v[52:55], v[148:151], v[116:119], v[52:55]
    ds_read_b64_tr_b16 v[132:133], v29 offset:0
    v_mfma_f32_16x16x32_bf16 v[56:59], v[152:155], v[112:115], v[56:59]
    ds_read_b64_tr_b16 v[134:135], v29 offset:2048
    v_mfma_f32_16x16x32_bf16 v[60:63], v[152:155], v[116:119], v[60:63]
    ds_read_b64_tr_b16 v[136:137], v30 offset:0
    v_mfma_f32_16x16x32_bf16 v[64:67], v[156:159], v[112:115], v[64:67]
    ds_read_b64_tr_b16 v[138:139], v30 offset:1024
    v_mfma_f32_16x16x32_bf16 v[68:71], v[156:159], v[116:119], v[68:71]
    ds_read_b64_tr_b16 v[140:141], v31 offset:0
    v_mfma_f32_16x16x32_bf16 v[72:75], v[112:115], v[160:163], v[72:75]
    ds_read_b64_tr_b16 v[142:143], v31 offset:1024
    v_mfma_f32_16x16x32_bf16 v[76:79], v[116:119], v[160:163], v[76:79]
    v_mfma_f32_16x16x32_bf16 v[80:83], v[112:115], v[164:167], v[80:83]
    v_mfma_f32_16x16x32_bf16 v[84:87], v[116:119], v[164:167], v[84:87]
    s_waitcnt lgkmcnt(0)
    v_mfma_f32_16x16x32_bf16 v[88:91], v[104:107], v[104:107], v[88:91]
    ds_read_b128 v[112:115], v24 offset:0
    ds_read_b128 v[116:119], v24 offset:2048
    v_mfma_f32_16x16x32_bf16 v[92:95], v[108:111], v[108:111], v[92:95]
    ds_read_b128 v[172:175], v33 offset:64
    ds_read_b64_tr_b16 v[144:145], v26 offset:4096
    v_mfma_f32_16x16x32_bf16 v[96:99], v[168:171], v[104:107], v[96:99]
    ds_read_b64_tr_b16 v[146:147], v26 offset:6144
    v_mfma_f32_16x16x32_bf16 v[100:103], v[168:171], v[108:111], v[100:103]
    ds_read_b64_tr_b16 v[148:149], v27 offset:4096
    v_mfma_f32_16x16x32_bf16 v[40:43], v[120:123], v[104:107], v[40:43]
    ds_read_b64_tr_b16 v[150:151], v27 offset:6144
    v_mfma_f32_16x16x32_bf16 v[44:47], v[120:123], v[108:111], v[44:47]
    ds_read_b64_tr_b16 v[152:153], v28 offset:4096
    v_mfma_f32_16x16x32_bf16 v[48:51], v[124:127], v[104:107], v[48:51]
    ds_read_b64_tr_b16 v[154:155], v28 offset:6144
    v_mfma_f32_16x16x32_bf16 v[52:55], v[124:127], v[108:111], v[52:55]
    ds_read_b64_tr_b16 v[156:157], v29 offset:4096
    v_mfma_f32_16x16x32_bf16 v[56:59], v[128:131], v[104:107], v[56:59]
    ds_read_b64_tr_b16 v[158:159], v29 offset:6144
    v_mfma_f32_16x16x32_bf16 v[60:63], v[128:131], v[108:111], v[60:63]
    ds_read_b64_tr_b16 v[160:161], v30 offset:2048
    v_mfma_f32_16x16x32_bf16 v[64:67], v[132:135], v[104:107], v[64:67]
    ds_read_b64_tr_b16 v[162:163], v30 offset:3072
    v_mfma_f32_16x16x32_bf16 v[68:71], v[132:135], v[108:111], v[68:71]
    ds_read_b64_tr_b16 v[164:165], v31 offset:2048
    v_mfma_f32_16x16x32_bf16 v[72:75], v[104:107], v[136:139], v[72:75]
    ds_read_b64_tr_b16 v[166:167], v31 offset:3072
    v_mfma_f32_16x16x32_bf16 v[76:79], v[108:111], v[136:139], v[76:79]
    v_mfma_f32_16x16x32_bf16 v[80:83], v[104:107], v[140:143], v[80:83]
    v_mfma_f32_16x16x32_bf16 v[84:87], v[108:111], v[140:143], v[84:87]
    s_waitcnt lgkmcnt(0)
    s_barrier
    global_load_dword v36, v3, s[24:25] sc1
    v_mfma_f32_16x16x32_bf16 v[88:91], v[112:115], v[112:115], v[88:91]
    ds_read_b128 v[104:107], v23 offset:16384
    ds_read_b128 v[108:111], v23 offset:18432
    v_mfma_f32_16x16x32_bf16 v[92:95], v[116:119], v[116:119], v[92:95]
    s_add_u32 s51, s50, 896
    s_and_b32 s51, s51, 1023
    v_add_u32 v33, s51, v32
    ds_read_b128 v[168:171], v33 offset:0
    ds_read_b64_tr_b16 v[120:121], v26 offset:12288
    v_mfma_f32_16x16x32_bf16 v[96:99], v[172:175], v[112:115], v[96:99]
    ds_read_b64_tr_b16 v[122:123], v26 offset:14336
    v_mfma_f32_16x16x32_bf16 v[100:103], v[172:175], v[116:119], v[100:103]
    ds_read_b64_tr_b16 v[124:125], v27 offset:12288
    v_mfma_f32_16x16x32_bf16 v[40:43], v[144:147], v[112:115], v[40:43]
    ds_read_b64_tr_b16 v[126:127], v27 offset:14336
    v_mfma_f32_16x16x32_bf16 v[44:47], v[144:147], v[116:119], v[44:47]
    ds_read_b64_tr_b16 v[128:129], v28 offset:12288
    v_mfma_f32_16x16x32_bf16 v[48:51], v[148:151], v[112:115], v[48:51]
    ds_read_b64_tr_b16 v[130:131], v28 offset:14336
    v_mfma_f32_16x16x32_bf16 v[52:55], v[148:151], v[116:119], v[52:55]
    ds_read_b64_tr_b16 v[132:133], v29 offset:12288
    v_mfma_f32_16x16x32_bf16 v[56:59], v[152:155], v[112:115], v[56:59]
    ds_read_b64_tr_b16 v[134:135], v29 offset:14336
    v_mfma_f32_16x16x32_bf16 v[60:63], v[152:155], v[116:119], v[60:63]
    ds_read_b64_tr_b16 v[136:137], v30 offset:12288
    v_mfma_f32_16x16x32_bf16 v[64:67], v[156:159], v[112:115], v[64:67]
    ds_read_b64_tr_b16 v[138:139], v30 offset:13312
    v_mfma_f32_16x16x32_bf16 v[68:71], v[156:159], v[116:119], v[68:71]
    ds_read_b64_tr_b16 v[140:141], v31 offset:12288
    v_mfma_f32_16x16x32_bf16 v[72:75], v[112:115], v[160:163], v[72:75]
    ds_read_b64_tr_b16 v[142:143], v31 offset:13312
    v_mfma_f32_16x16x32_bf16 v[76:79], v[116:119], v[160:163], v[76:79]
    v_mfma_f32_16x16x32_bf16 v[80:83], v[112:115], v[164:167], v[80:83]
    v_mfma_f32_16x16x32_bf16 v[84:87], v[116:119], v[164:167], v[84:87]
    s_waitcnt lgkmcnt(0)
    v_mfma_f32_16x16x32_bf16 v[88:91], v[104:107], v[104:107], v[88:91]
    ds_read_b128 v[112:115], v24 offset:16384
    ds_read_b128 v[116:119], v24 offset:18432
    v_mfma_f32_16x16x32_bf16 v[92:95], v[108:111], v[108:111], v[92:95]
    ds_read_b128 v[172:175], v33 offset:64
    ds_read_b64_tr_b16 v[144:145], v26 offset:16384
    v_mfma_f32_16x16x32_bf16 v[96:99], v[168:171], v[104:107], v[96:99]
    ds_read_b64_tr_b16 v[146:147], v26 offset:18432
    v_mfma_f32_16x16x32_bf16 v[100:103], v[168:171], v[108:111], v[100:103]
    ds_read_b64_tr_b16 v[148:149], v27 offset:16384
    v_mfma_f32_16x16x32_bf16 v[40:43], v[120:123], v[104:107], v[40:43]
    ds_read_b64_tr_b16 v[150:151], v27 offset:18432
    v_mfma_f32_16x16x32_bf16 v[44:47], v[120:123], v[108:111], v[44:47]
    ds_read_b64_tr_b16 v[152:153], v28 offset:16384
    v_mfma_f32_16x16x32_bf16 v[48:51], v[124:127], v[104:107], v[48:51]
    ds_read_b64_tr_b16 v[154:155], v28 offset:18432
    v_mfma_f32_16x16x32_bf16 v[52:55], v[124:127], v[108:111], v[52:55]
    ds_read_b64_tr_b16 v[156:157], v29 offset:16384
    v_mfma_f32_16x16x32_bf16 v[56:59], v[128:131], v[104:107], v[56:59]
    ds_read_b64_tr_b16 v[158:159], v29 offset:18432
    v_mfma_f32_16x16x32_bf16 v[60:63], v[128:131], v[108:111], v[60:63]
    ds_read_b64_tr_b16 v[160:161], v30 offset:14336
    v_mfma_f32_16x16x32_bf16 v[64:67], v[132:135], v[104:107], v[64:67]
    ds_read_b64_tr_b16 v[162:163], v30 offset:15360
    v_mfma_f32_16x16x32_bf16 v[68:71], v[132:135], v[108:111], v[68:71]
    ds_read_b64_tr_b16 v[164:165], v31 offset:14336
    v_mfma_f32_16x16x32_bf16 v[72:75], v[104:107], v[136:139], v[72:75]
    ds_read_b64_tr_b16 v[166:167], v31 offset:15360
    v_mfma_f32_16x16x32_bf16 v[76:79], v[108:111], v[136:139], v[76:79]
    v_mfma_f32_16x16x32_bf16 v[80:83], v[104:107], v[140:143], v[80:83]
    v_mfma_f32_16x16x32_bf16 v[84:87], v[108:111], v[140:143], v[84:87]
    s_waitcnt lgkmcnt(0)
    v_mfma_f32_16x16x32_bf16 v[88:91], v[112:115], v[112:115], v[88:91]
    v_mfma_f32_16x16x32_bf16 v[92:95], v[116:119], v[116:119], v[92:95]
    v_mfma_f32_16x16x32_bf16 v[96:99], v[172:175], v[112:115], v[96:99]
    v_mfma_f32_16x16x32_bf16 v[100:103], v[172:175], v[116:119], v[100:103]
    v_mfma_f32_16x16x32_bf16 v[40:43], v[144:147], v[112:115], v[40:43]
    v_mfma_f32_16x16x32_bf16 v[44:47], v[144:147], v[116:119], v[44:47]
    v_mfma_f32_16x16x32_bf16 v[48:51], v[148:151], v[112:115], v[48:51]
    v_mfma_f32_16x16x32_bf16 v[52:55], v[148:151], v[116:119], v[52:55]
    v_mfma_f32_16x16x32_bf16 v[56:59], v[152:155], v[112:115], v[56:59]
    v_mfma_f32_16x16x32_bf16 v[60:63], v[152:155], v[116:119], v[60:63]
    v_mfma_f32_16x16x32_bf16 v[64:67], v[156:159], v[112:115], v[64:67]
    v_mfma_f32_16x16x32_bf16 v[68:71], v[156:159], v[116:119], v[68:71]
    v_mfma_f32_16x16x32_bf16 v[72:75], v[112:115], v[160:163], v[72:75]
    v_mfma_f32_16x16x32_bf16 v[76:79], v[116:119], v[160:163], v[76:79]
    v_mfma_f32_16x16x32_bf16 v[80:83], v[112:115], v[164:167], v[80:83]
    v_mfma_f32_16x16x32_bf16 v[84:87], v[116:119], v[164:167], v[84:87]
    v_mul_f32 v40, s46, v40
    v_mul_f32 v41, s46, v41
    v_mul_f32 v42, s46, v42
    v_mul_f32 v43, s46, v43
    v_mul_f32 v44, s46, v44
    v_mul_f32 v45, s46, v45
    v_mul_f32 v46, s46, v46
    v_mul_f32 v47, s46, v47
    v_cvt_pk_bf16_f32 v104, v40, v41
    v_cvt_pk_bf16_f32 v105, v42, v43
    v_cvt_pk_bf16_f32 v106, v44, v45
    v_cvt_pk_bf16_f32 v107, v46, v47
    v_mul_f32 v48, s46, v48
    v_mul_f32 v49, s46, v49
    v_mul_f32 v50, s46, v50
    v_mul_f32 v51, s46, v51
    v_mul_f32 v52, s46, v52
    v_mul_f32 v53, s46, v53
    v_mul_f32 v54, s46, v54
    v_mul_f32 v55, s46, v55
    v_cvt_pk_bf16_f32 v108, v48, v49
    v_cvt_pk_bf16_f32 v109, v50, v51
    v_cvt_pk_bf16_f32 v110, v52, v53
    v_cvt_pk_bf16_f32 v111, v54, v55
    v_permlane16_swap_b32 v104, v106
    v_permlane16_swap_b32 v105, v107
    buffer_store_dwordx4 v[104:107], v2, s[36:39], s40 offen sc1
    v_mul_f32 v56, s46, v56
    v_mul_f32 v57, s46, v57
    v_mul_f32 v58, s46, v58
    v_mul_f32 v59, s46, v59
    v_mul_f32 v60, s46, v60
    v_mul_f32 v61, s46, v61
    v_mul_f32 v62, s46, v62
    v_mul_f32 v63, s46, v63
    v_cvt_pk_bf16_f32 v112, v56, v57
    v_cvt_pk_bf16_f32 v113, v58, v59
    v_cvt_pk_bf16_f32 v114, v60, v61
    v_cvt_pk_bf16_f32 v115, v62, v63
    v_permlane16_swap_b32 v108, v110
    v_permlane16_swap_b32 v109, v111
    buffer_store_dwordx4 v[108:111], v2, s[36:39], s41 offen sc1
    v_mul_f32 v64, s46, v64
    v_mul_f32 v65, s46, v65
    v_mul_f32 v66, s46, v66
    v_mul_f32 v67, s46, v67
    v_mul_f32 v68, s46, v68
    v_mul_f32 v69, s46, v69
    v_mul_f32 v70, s46, v70
    v_mul_f32 v71, s46, v71
    v_cvt_pk_bf16_f32 v116, v64, v65
    v_cvt_pk_bf16_f32 v117, v66, v67
    v_cvt_pk_bf16_f32 v118, v68, v69
    v_cvt_pk_bf16_f32 v119, v70, v71
    v_permlane16_swap_b32 v112, v114
    v_permlane16_swap_b32 v113, v115
    buffer_store_dwordx4 v[112:115], v2, s[36:39], s42 offen sc1
    v_cvt_pk_bf16_f32 v120, v72, v73
    v_cvt_pk_bf16_f32 v121, v74, v75
    v_cvt_pk_bf16_f32 v122, v76, v77
    v_cvt_pk_bf16_f32 v123, v78, v79
    v_permlane16_swap_b32 v116, v118
    v_permlane16_swap_b32 v117, v119
    buffer_store_dwordx4 v[116:119], v2, s[36:39], s43 offen sc1
    v_cvt_pk_bf16_f32 v124, v80, v81
    v_cvt_pk_bf16_f32 v125, v82, v83
    v_cvt_pk_bf16_f32 v126, v84, v85
    v_cvt_pk_bf16_f32 v127, v86, v87
    v_permlane32_swap_b32 v120, v122
    v_permlane32_swap_b32 v121, v123
    buffer_store_dwordx4 v[120:123], v2, s[36:39], s44 offen sc1
    v_permlane32_swap_b32 v124, v126
    v_permlane32_swap_b32 v125, v127
    buffer_store_dwordx4 v[124:127], v2, s[36:39], s45 offen sc1
    v_cndmask_b32 v132, v88, v89, s[12:13]
    v_cndmask_b32 v140, v92, v93, s[12:13]
    v_mul_f32 v134, 1069066811, v97
    v_mul_f32 v142, 1069066811, v101
    v_cndmask_b32 v132, v132, v90, s[14:15]
    v_cndmask_b32 v140, v140, v94, s[14:15]
    v_mul_f32 v133, 989855744, v96
    v_mul_f32 v141, 989855744, v100
    v_cndmask_b32 v132, v132, v91, s[20:21]
    v_cndmask_b32 v140, v140, v95, s[20:21]
    v_exp_f32 v130, v134
    v_exp_f32 v138, v142
    v_mul_f32 v132, 989855744, v132
    v_mul_f32 v140, 989855744, v140
    v_exp_f32 v131, -v134
    v_exp_f32 v139, -v142
    v_fma_f32 v132, -v133, v133, v132
    v_fma_f32 v140, -v141, v141, v140
    v_add_f32 v130, 1.0, v130
    v_add_f32 v138, 1.0, v138
    v_max_f32 v132, 0, v132
    v_max_f32 v140, 0, v140
    v_add_f32 v131, 1.0, v131
    v_add_f32 v139, 1.0, v139
    v_add_f32 v132, 925353388, v132
    v_add_f32 v140, 925353388, v140
    v_min_f32 v130, 1900671690, v130
    v_min_f32 v138, 1900671690, v138
    v_rsq_f32 v128, v132
    v_rsq_f32 v136, v140
    v_rcp_f32 v131, v131
    v_rcp_f32 v139, v139
    v_mul_f32 v129, -v133, v128
    v_mul_f32 v137, -v141, v136
    s_mov_b32 exec_lo, 0x00f0000f
    s_mov_b32 exec_hi, 0xf0000f00
    ds_write_b128 v34, v[128:131]
    ds_write_b128 v34, v[136:139] offset:256
    v_rcp_f32 v135, v130
    v_rcp_f32 v143, v138
    buffer_store_dword v135, v35, s[36:39], 0 offen sc1
    buffer_store_dword v143, v35, s[36:39], 0 offen offset:64 sc1
    s_mov_b64 exec, -1
    v_mov_b32 v96, 0x3f803f80
    v_mov_b32 v97, 0x3f803f80
    v_mov_b32 v98, 0x3f803f80
    v_mov_b32 v99, 0x3f803f80
    s_waitcnt vmcnt(8)
    v_readfirstlane_b32 s58, v36
    s_mov_b32 s99, 200000
    s_cmp_lg_u32 s58, 0
    s_cbranch_scc0 L_n_17
L_nk_18:
    s_waitcnt lgkmcnt(0)
    s_setprio 3
    s_barrier
    s_waitcnt vmcnt(2)
    s_sub_u32 s60, s58, s100
    s_sub_u32 s60, s60, 3
    s_cmp_eq_u32 s53, 0
    s_cselect_b32 s100, s60, 1
    s_add_u32 s59, s3, 0
    s_atomic_add s100, s[26:27], s59
    s_mov_b32 s40, s16
    s_mov_b32 s41, s17
    s_mov_b32 s42, 1835008
    s_mov_b32 s43, 0x20000
    s_lshl2_add_u32 s59, s2, s53
    s_mul_i32 s60, s59, 1792
    s_lshl_b32 s59, s59, 9
    v_lshlrev_b32 v4, 7, v1
    s_mov_b64 exec, 0x3fff
    s_mov_b64 exec, 15
    buffer_load_dword v0, v4, s[28:31], s59 offen
    s_mov_b64 exec, -1
    ds_read_b64_tr_b16 v[40:41], v37 offset:32768
    ds_read_b64_tr_b16 v[42:43], v37 offset:34304
    ds_read_b64_tr_b16 v[44:45], v37 offset:35840
    ds_read_b64_tr_b16 v[46:47], v37 offset:37376
    ds_read_b64_tr_b16 v[48:49], v37 offset:38912
    ds_read_b64_tr_b16 v[50:51], v37 offset:40448
    ds_read_b64_tr_b16 v[52:53], v37 offset:41984
    ds_read_b64_tr_b16 v[54:55], v37 offset:43520
    ds_read_b64_tr_b16 v[56:57], v38 offset:24576
    ds_read_b64_tr_b16 v[58:59], v38 offset:26112
    ds_read_b64_tr_b16 v[60:61], v38 offset:27648
    ds_read_b64_tr_b16 v[62:63], v38 offset:29184
    s_waitcnt lgkmcnt(10)
    v_mfma_f32_16x16x32_bf16 v[88:91], v[40:43], v[96:99], 0
    ds_read_b64_tr_b16 v[64:65], v38 offset:30720
    ds_read_b64_tr_b16 v[66:67], v38 offset:32256
    s_waitcnt lgkmcnt(10)
    v_mfma_f32_16x16x32_bf16 v[88:91], v[44:47], v[96:99], v[88:91]
    ds_read_b64_tr_b16 v[68:69], v38 offset:33792
    ds_read_b64_tr_b16 v[70:71], v38 offset:35328
    s_waitcnt lgkmcnt(10)
    v_mfma_f32_16x16x32_bf16 v[88:91], v[48:51], v[96:99], v[88:91]
    ds_read_b64_tr_b16 v[72:73], v37 offset:0
    ds_read_b64_tr_b16 v[74:75], v37 offset:1536
    s_waitcnt lgkmcnt(10)
    v_mfma_f32_16x16x32_bf16 v[88:91], v[52:55], v[96:99], v[88:91]
    ds_read_b64_tr_b16 v[76:77], v37 offset:3072
    ds_read_b64_tr_b16 v[78:79], v37 offset:4608
    s_waitcnt lgkmcnt(10)
    v_mfma_f32_16x16x32_bf16 v[88:91], v[56:59], v[96:99], v[88:91]
    ds_read_b64_tr_b16 v[80:81], v37 offset:6144
    ds_read_b64_tr_b16 v[82:83], v37 offset:7680
    s_waitcnt lgkmcnt(10)
    v_mfma_f32_16x16x32_bf16 v[88:91], v[60:63], v[96:99], v[88:91]
    ds_read_b64_tr_b16 v[84:85], v37 offset:9216
    ds_read_b64_tr_b16 v[86:87], v37 offset:10752
    s_waitcnt lgkmcnt(10)
    v_mfma_f32_16x16x32_bf16 v[88:91], v[64:67], v[96:99], v[88:91]
    ds_read_b64_tr_b16 v[40:41], v38 offset:0
    ds_read_b64_tr_b16 v[42:43], v38 offset:1536
    s_waitcnt lgkmcnt(10)
    v_mfma_f32_16x16x32_bf16 v[88:91], v[68:71], v[96:99], v[88:91]
    ds_read_b64_tr_b16 v[44:45], v38 offset:3072
    ds_read_b64_tr_b16 v[46:47], v38 offset:4608
    s_waitcnt lgkmcnt(10)
    v_mfma_f32_16x16x32_bf16 v[88:91], v[72:75], v[96:99], v[88:91]
    ds_read_b64_tr_b16 v[48:49], v38 offset:6144
    ds_read_b64_tr_b16 v[50:51], v38 offset:7680
    s_waitcnt lgkmcnt(10)
    v_mfma_f32_16x16x32_bf16 v[88:91], v[76:79], v[96:99], v[88:91]
    ds_read_b64_tr_b16 v[52:53], v38 offset:9216
    ds_read_b64_tr_b16 v[54:55], v38 offset:10752
    s_waitcnt lgkmcnt(10)
    v_mfma_f32_16x16x32_bf16 v[88:91], v[80:83], v[96:99], v[88:91]
    s_waitcnt lgkmcnt(8)
    v_mfma_f32_16x16x32_bf16 v[88:91], v[84:87], v[96:99], v[88:91]
    s_waitcnt lgkmcnt(6)
    v_mfma_f32_16x16x32_bf16 v[88:91], v[40:43], v[96:99], v[88:91]
    s_waitcnt lgkmcnt(4)
    v_mfma_f32_16x16x32_bf16 v[88:91], v[44:47], v[96:99], v[88:91]
    s_waitcnt lgkmcnt(2)
    v_mfma_f32_16x16x32_bf16 v[88:91], v[48:51], v[96:99], v[88:91]
    s_waitcnt lgkmcnt(0)
    v_mfma_f32_16x16x32_bf16 v[88:91], v[52:55], v[96:99], v[88:91]
    v_mov_b32 v8, 156416
    v_mov_b32 v9, 1
    s_mov_b32 exec_lo, 0x00010001
    s_mov_b32 exec_hi, 0x00010001
    s_nop 3
    ds_write_b128 v39, v[88:91]
    s_mov_b64 exec, -1
    s_mov_b64 exec, 1
    ds_add_u32 v8, v9 offset:0
    s_mov_b64 exec, -1
    s_mov_b64 exec, 1
    ds_add_u32 v8, v9 offset:8
    s_mov_b64 exec, -1
    ds_read_b32 v24, v13
    ds_read_b32 v25, v13 offset:512
    s_setprio 3
    s_add_u32 m0, s1, 16384
    s_nop 0
    buffer_load_dwordx4 v10, s[40:43], s0 offen lds
    buffer_load_dwordx4 v11, s[40:43], s0 offen offset:1024 lds
    s_add_u32 s0, s0, 16384
    s_cmp_lt_u32 s0, 458752
    s_cselect_b32 s0, s0, 0
    s_add_u32 m0, s1, 24576
    s_nop 0
    buffer_load_dwordx4 v10, s[40:43], s0 offen lds
    buffer_load_dwordx4 v11, s[40:43], s0 offen offset:1024 lds
    s_add_u32 s0, s0, 16384
    s_cmp_lt_u32 s0, 458752
    s_cselect_b32 s0, s0, 0
    ds_read_b32 v23, v8 offset:4
    s_waitcnt lgkmcnt(0)
    v_readfirstlane_b32 s59, v23
    s_mov_b32 s99, 1600000
    s_cmp_lt_u32 s59, 4
    s_cbranch_scc1 L_lw_19
L_lo_20:
    s_add_u32 m0, s1, 98304
    s_nop 0
    buffer_load_dwordx4 v10, s[40:43], s0 offen lds
    buffer_load_dwordx4 v11, s[40:43], s0 offen offset:1024 lds
    s_add_u32 s0, s0, 16384
    s_cmp_lt_u32 s0, 458752
    s_cselect_b32 s0, s0, 0
    s_add_u32 m0, s1, 106496
    s_nop 0
    buffer_load_dwordx4 v10, s[40:43], s0 offen lds
    buffer_load_dwordx4 v11, s[40:43], s0 offen offset:1024 lds
    s_add_u32 s0, s0, 16384
    s_cmp_lt_u32 s0, 458752
    s_cselect_b32 s0, s0, 0
    s_add_u32 m0, s1, 114688
    s_nop 0
    buffer_load_dwordx4 v10, s[40:43], s0 offen lds
    buffer_load_dwordx4 v11, s[40:43], s0 offen offset:1024 lds
    s_add_u32 s0, s0, 16384
    s_cmp_lt_u32 s0, 458752
    s_cselect_b32 s0, s0, 0
    s_cmp_lg_u32 s52, 4
    s_cbranch_scc1 L_a_ne
    s_mov_b32 s19, 0
    s_atomic_add s19, s[26:27], s4 glc
    s_mov_b32 s22, 0
    s_atomic_add s22, s[26:27], s5 glc
    s_mov_b32 s23, 0
    s_atomic_add s23, s[26:27], s6 glc
    s_mov_b32 s60, 0
    s_atomic_add s60, s[26:27], s7 glc
    s_mov_b32 s61, 0
    s_atomic_add s61, s[26:27], s8 glc
    s_mov_b32 s62, 0
    s_atomic_add s62, s[26:27], s9 glc
    s_mov_b32 s63, 0
    s_atomic_add s63, s[26:27], s18 glc
L_a_ne:
    s_add_u32 m0, s1, 122880
    s_nop 0
    buffer_load_dwordx4 v10, s[40:43], s0 offen lds
    buffer_load_dwordx4 v11, s[40:43], s0 offen offset:1024 lds
    s_add_u32 s0, s0, 16384
    s_cmp_lt_u32 s0, 458752
    s_cselect_b32 s0, s0, 0
    s_add_u32 m0, s1, 131072
    s_nop 0
    buffer_load_dwordx4 v10, s[40:43], s0 offen lds
    buffer_load_dwordx4 v11, s[40:43], s0 offen offset:1024 lds
    s_add_u32 s0, s0, 16384
    s_cmp_lt_u32 s0, 458752
    s_cselect_b32 s0, s0, 0
    s_add_u32 m0, s1, 139264
    s_nop 0
    buffer_load_dwordx4 v10, s[40:43], s0 offen lds
    buffer_load_dwordx4 v11, s[40:43], s0 offen offset:1024 lds
    s_add_u32 s0, s0, 16384
    s_cmp_lt_u32 s0, 458752
    s_cselect_b32 s0, s0, 0
    s_cmp_lg_u32 s52, 4
    s_cbranch_scc1 L_a_np
    s_mov_b32 s99, 200000
    s_waitcnt lgkmcnt(0)
    s_xor_b32 s19, s19, s58
    s_xor_b32 s22, s22, s58
    s_xor_b32 s23, s23, s58
    s_xor_b32 s60, s60, s58
    s_xor_b32 s61, s61, s58
    s_xor_b32 s62, s62, s58
    s_xor_b32 s63, s63, s58
    s_or_b32 s19, s19, s22
    s_or_b32 s19, s19, s23
    s_or_b32 s19, s19, s60
    s_or_b32 s19, s19, s61
    s_or_b32 s19, s19, s62
    s_or_b32 s19, s19, s63
    s_cbranch_scc1 L_poll_21
L_pout_22:
    ds_write_b32 v8, v9 offset:32
L_a_np:
    ds_read_b32 v23, v8 offset:32
    s_waitcnt lgkmcnt(0)
    v_readfirstlane_b32 s59, v23
    s_mov_b32 s99, 1600000
    s_cmp_lt_u32 s59, 1
    s_cbranch_scc1 L_lw_23
L_lo_24:
    buffer_load_dwordx4 v[68:71], v2, s[36:39], s47 offen offset:0
    s_add_u32 s59, s47, 2097152
    buffer_load_dwordx4 v[60:63], v2, s[36:39], s59 offen
    s_add_u32 s59, s47, 2088960
    s_cmp_gt_u32 s98, 0
    s_cselect_b32 s59, 33554432, s59
    buffer_load_dwordx4 v[28:31], v2, s[36:39], s59 offen
    s_add_u32 s59, s47, 2089984
    s_cmp_gt_u32 s98, 1
    s_cselect_b32 s59, 33554432, s59
    buffer_load_dwordx4 v[32:35], v2, s[36:39], s59 offen
    s_add_u32 s59, s47, 2091008
    s_cmp_gt_u32 s98, 2
    s_cselect_b32 s59, 33554432, s59
    buffer_load_dwordx4 v[36:39], v2, s[36:39], s59 offen
    s_add_u32 s59, s47, 4186112
    s_cmp_gt_u32 s98, 0
    s_cselect_b32 s59, 33554432, s59
    buffer_load_dwordx4 v[172:175], v12, s[36:39], s59 offen
    s_add_u32 s59, s47, 4194304
    buffer_load_dwordx4 v[236:239], v12, s[36:39], s59 offen
    s_add_u32 s59, s47, 2092032
    s_cmp_gt_u32 s98, 3
    s_cselect_b32 s59, 33554432, s59
    buffer_load_dwordx4 v[40:43], v2, s[36:39], s59 offen
    s_add_u32 s59, s47, 4187136
    s_cmp_gt_u32 s98, 1
    s_cselect_b32 s59, 33554432, s59
    buffer_load_dwordx4 v[180:183], v12, s[36:39], s59 offen
    s_add_u32 s59, s47, 2093056
    s_cmp_gt_u32 s98, 4
    s_cselect_b32 s59, 33554432, s59
    buffer_load_dwordx4 v[44:47], v2, s[36:39], s59 offen
    s_add_u32 s59, s47, 4188160
    s_cmp_gt_u32 s98, 2
    s_cselect_b32 s59, 33554432, s59
    buffer_load_dwordx4 v[188:191], v12, s[36:39], s59 offen
    s_add_u32 s59, s47, 2094080
    s_cmp_gt_u32 s98, 5
    s_cselect_b32 s59, 33554432, s59
    buffer_load_dwordx4 v[48:51], v2, s[36:39], s59 offen
    s_add_u32 s59, s47, 4189184
    s_cmp_gt_u32 s98, 3
    s_cselect_b32 s59, 33554432, s59
    buffer_load_dwordx4 v[196:199], v12, s[36:39], s59 offen
    s_add_u32 s59, s47, 2095104
    s_cmp_gt_u32 s98, 6
    s_cselect_b32 s59, 33554432, s59
    buffer_load_dwordx4 v[52:55], v2, s[36:39], s59 offen
    s_add_u32 s59, s47, 4190208
    s_cmp_gt_u32 s98, 4
    s_cselect_b32 s59, 33554432, s59
    buffer_load_dwordx4 v[204:207], v12, s[36:39], s59 offen
    s_add_u32 s59, s47, 2096128
    s_cmp_gt_u32 s98, 7
    s_cselect_b32 s59, 33554432, s59
    buffer_load_dwordx4 v[56:59], v2, s[36:39], s59 offen
    s_add_u32 s59, s47, 4191232
    s_cmp_gt_u32 s98, 5
    s_cselect_b32 s59, 33554432, s59
    buffer_load_dwordx4 v[212:215], v12, s[36:39], s59 offen
    s_add_u32 s59, s47, 4192256
    s_cmp_gt_u32 s98, 6
    s_cselect_b32 s59, 33554432, s59
    buffer_load_dwordx4 v[220:223], v12, s[36:39], s59 offen
    buffer_load_dwordx4 v[72:75], v2, s[36:39], s47 offen offset:1024
    s_add_u32 s59, s47, 2098176
    buffer_load_dwordx4 v[64:67], v2, s[36:39], s59 offen
    s_add_u32 s59, s47, 4193280
    s_cmp_gt_u32 s98, 7
    s_cselect_b32 s59, 33554432, s59
    buffer_load_dwordx4 v[228:231], v12, s[36:39], s59 offen
    s_add_u32 s59, s47, 4195328
    buffer_load_dwordx4 v[244:247], v12, s[36:39], s59 offen
    s_waitcnt vmcnt(22)
    ds_write_b32 v14, v9
    s_setprio 1
    ds_read_b32 v23, v8 offset:12
    s_waitcnt lgkmcnt(0)
    v_readfirstlane_b32 s59, v23
    s_mov_b32 s99, 1600000
    s_cmp_lt_u32 s59, 4
    s_cbranch_scc1 L_lw_25
L_lo_26:
    s_waitcnt vmcnt(20)
    v_mfma_f32_32x32x16_bf16 v[92:107], v[60:63], v[68:71], 0
    s_waitcnt vmcnt(19)
    v_mfma_f32_32x32x16_bf16 v[108:123], v[28:31], v[68:71], 0
    s_waitcnt vmcnt(18)
    v_mfma_f32_32x32x16_bf16 v[76:91], v[32:35], v[68:71], 0
    s_nop 9
    v_cndmask_b32 v108, v108, v92, s[64:65]
    v_cndmask_b32 v109, v109, v93, s[66:67]
    v_cndmask_b32 v110, v110, v94, s[68:69]
    v_cndmask_b32 v111, v111, v95, s[70:71]
    v_cndmask_b32 v112, v112, v96, s[72:73]
    v_cndmask_b32 v113, v113, v97, s[74:75]
    v_cndmask_b32 v114, v114, v98, s[76:77]
    v_cndmask_b32 v115, v115, v99, s[78:79]
    v_cndmask_b32 v116, v116, v100, s[80:81]
    v_cndmask_b32 v117, v117, v101, s[82:83]
    v_cndmask_b32 v118, v118, v102, s[84:85]
    v_cndmask_b32 v119, v119, v103, s[86:87]
    v_cndmask_b32 v120, v120, v104, s[88:89]
    v_cndmask_b32 v121, v121, v105, s[90:91]
    v_cndmask_b32 v122, v122, v106, s[92:93]
    v_cndmask_b32 v123, v123, v107, s[94:95]
    v_exp_f32 v108, v108
    v_exp_f32 v109, v109
    v_exp_f32 v110, v110
    v_exp_f32 v111, v111
    v_exp_f32 v112, v112
    v_exp_f32 v113, v113
    v_exp_f32 v114, v114
    v_exp_f32 v115, v115
    v_exp_f32 v116, v116
    v_exp_f32 v117, v117
    v_exp_f32 v118, v118
    v_exp_f32 v119, v119
    v_exp_f32 v120, v120
    v_exp_f32 v121, v121
    v_exp_f32 v122, v122
    v_exp_f32 v123, v123
    v_cvt_pk_bf16_f32 v108, v108, v109
    v_cvt_pk_bf16_f32 v109, v110, v111
    v_cvt_pk_bf16_f32 v110, v112, v113
    v_cvt_pk_bf16_f32 v111, v114, v115
    v_cvt_pk_bf16_f32 v112, v116, v117
    v_cvt_pk_bf16_f32 v113, v118, v119
    v_cvt_pk_bf16_f32 v114, v120, v121
    v_cvt_pk_bf16_f32 v115, v122, v123
    v_and_b32 v116, v108, v15
    v_and_b32 v117, v109, v16
    v_and_b32 v118, v110, v17
    v_and_b32 v119, v111, v18
    v_and_b32 v120, v112, v19
    v_and_b32 v121, v113, v20
    v_and_b32 v122, v114, v21
    v_and_b32 v123, v115, v22
    v_xor_b32 v108, v108, v116
    v_xor_b32 v109, v109, v117
    v_xor_b32 v110, v110, v118
    v_xor_b32 v111, v111, v119
    v_xor_b32 v112, v112, v120
    v_xor_b32 v113, v113, v121
    v_xor_b32 v114, v114, v122
    v_xor_b32 v115, v115, v123
    s_waitcnt vmcnt(16)
    v_permlane16_swap_b32 v172, v176
    v_permlane16_swap_b32 v173, v177
    v_permlane16_swap_b32 v174, v178
    v_permlane16_swap_b32 v175, v179
    s_waitcnt vmcnt(15)
    v_permlane16_swap_b32 v236, v240
    v_permlane16_swap_b32 v237, v241
    v_permlane16_swap_b32 v238, v242
    v_permlane16_swap_b32 v239, v243
    v_mfma_f32_32x32x16_bf16 v[92:107], v[36:39], v[68:71], 0
    v_exp_f32 v76, v76
    v_exp_f32 v77, v77
    v_exp_f32 v78, v78
    v_exp_f32 v79, v79
    v_mfma_f32_32x32x16_bf16 v[140:155], v[172:175], v[108:111], 0
    v_exp_f32 v80, v80
    v_exp_f32 v81, v81
    v_exp_f32 v82, v82
    v_exp_f32 v83, v83
    v_mfma_f32_32x32x16_bf16 v[140:155], v[176:179], v[112:115], v[140:155]
    v_exp_f32 v84, v84
    v_exp_f32 v85, v85
    v_exp_f32 v86, v86
    v_exp_f32 v87, v87
    v_mfma_f32_32x32x16_bf16 v[140:155], v[236:239], v[116:119], v[140:155]
    v_exp_f32 v88, v88
    v_exp_f32 v89, v89
    v_exp_f32 v90, v90
    v_exp_f32 v91, v91
    s_waitcnt vmcnt(13)
    v_permlane16_swap_b32 v180, v184
    v_permlane16_swap_b32 v181, v185
    v_permlane16_swap_b32 v182, v186
    v_permlane16_swap_b32 v183, v187
    v_cvt_pk_bf16_f32 v156, v76, v77
    v_cvt_pk_bf16_f32 v157, v78, v79
    v_cvt_pk_bf16_f32 v158, v80, v81
    v_cvt_pk_bf16_f32 v159, v82, v83
    v_cvt_pk_bf16_f32 v160, v84, v85
    v_cvt_pk_bf16_f32 v161, v86, v87
    v_cvt_pk_bf16_f32 v162, v88, v89
    v_cvt_pk_bf16_f32 v163, v90, v91
    v_mfma_f32_32x32x16_bf16 v[76:91], v[40:43], v[68:71], 0
    v_exp_f32 v92, v92
    v_exp_f32 v93, v93
    v_exp_f32 v94, v94
    v_exp_f32 v95, v95
    v_mfma_f32_32x32x16_bf16 v[140:155], v[240:243], v[120:123], v[140:155]
    v_exp_f32 v96, v96
    v_exp_f32 v97, v97
    v_exp_f32 v98, v98
    v_exp_f32 v99, v99
    v_mfma_f32_32x32x16_bf16 v[140:155], v[180:183], v[156:159], v[140:155]
    v_exp_f32 v100, v100
    v_exp_f32 v101, v101
    v_exp_f32 v102, v102
    v_exp_f32 v103, v103
    v_mfma_f32_32x32x16_bf16 v[140:155], v[184:187], v[160:163], v[140:155]
    v_exp_f32 v104, v104
    v_exp_f32 v105, v105
    v_exp_f32 v106, v106
    v_exp_f32 v107, v107
    s_waitcnt vmcnt(11)
    v_permlane16_swap_b32 v188, v192
    v_permlane16_swap_b32 v189, v193
    v_permlane16_swap_b32 v190, v194
    v_permlane16_swap_b32 v191, v195
    v_cvt_pk_bf16_f32 v164, v92, v93
    v_cvt_pk_bf16_f32 v165, v94, v95
    v_cvt_pk_bf16_f32 v166, v96, v97
    v_cvt_pk_bf16_f32 v167, v98, v99
    v_cvt_pk_bf16_f32 v168, v100, v101
    v_cvt_pk_bf16_f32 v169, v102, v103
    v_cvt_pk_bf16_f32 v170, v104, v105
    v_cvt_pk_bf16_f32 v171, v106, v107
    v_mfma_f32_32x32x16_bf16 v[92:107], v[44:47], v[68:71], 0
    v_exp_f32 v76, v76
    v_exp_f32 v77, v77
    v_exp_f32 v78, v78
    v_exp_f32 v79, v79
    v_mfma_f32_32x32x16_bf16 v[140:155], v[188:191], v[164:167], v[140:155]
    v_exp_f32 v80, v80
    v_exp_f32 v81, v81
    v_exp_f32 v82, v82
    v_exp_f32 v83, v83
    v_mfma_f32_32x32x16_bf16 v[140:155], v[192:195], v[168:171], v[140:155]
    v_exp_f32 v84, v84
    v_exp_f32 v85, v85
    v_exp_f32 v86, v86
    v_exp_f32 v87, v87
    v_exp_f32 v88, v88
    v_exp_f32 v89, v89
    v_exp_f32 v90, v90
    v_exp_f32 v91, v91
    s_waitcnt vmcnt(9)
    v_permlane16_swap_b32 v196, v200
    v_permlane16_swap_b32 v197, v201
    v_permlane16_swap_b32 v198, v202
    v_permlane16_swap_b32 v199, v203
    v_cvt_pk_bf16_f32 v156, v76, v77
    v_cvt_pk_bf16_f32 v157, v78, v79
    v_cvt_pk_bf16_f32 v158, v80, v81
    v_cvt_pk_bf16_f32 v159, v82, v83
    v_cvt_pk_bf16_f32 v160, v84, v85
    v_cvt_pk_bf16_f32 v161, v86, v87
    v_cvt_pk_bf16_f32 v162, v88, v89
    v_cvt_pk_bf16_f32 v163, v90, v91
    v_mfma_f32_32x32x16_bf16 v[76:91], v[48:51], v[68:71], 0
    v_exp_f32 v92, v92
    v_exp_f32 v93, v93
    v_exp_f32 v94, v94
    v_exp_f32 v95, v95
    v_mfma_f32_32x32x16_bf16 v[140:155], v[196:199], v[156:159], v[140:155]
    v_exp_f32 v96, v96
    v_exp_f32 v97, v97
    v_exp_f32 v98, v98
    v_exp_f32 v99, v99
    v_mfma_f32_32x32x16_bf16 v[140:155], v[200:203], v[160:163], v[140:155]
    v_exp_f32 v100, v100
    v_exp_f32 v101, v101
    v_exp_f32 v102, v102
    v_exp_f32 v103, v103
    v_exp_f32 v104, v104
    v_exp_f32 v105, v105
    v_exp_f32 v106, v106
    v_exp_f32 v107, v107
    s_waitcnt vmcnt(7)
    v_permlane16_swap_b32 v204, v208
    v_permlane16_swap_b32 v205, v209
    v_permlane16_swap_b32 v206, v210
    v_permlane16_swap_b32 v207, v211
    v_cvt_pk_bf16_f32 v164, v92, v93
    v_cvt_pk_bf16_f32 v165, v94, v95
    v_cvt_pk_bf16_f32 v166, v96, v97
    v_cvt_pk_bf16_f32 v167, v98, v99
    v_cvt_pk_bf16_f32 v168, v100, v101
    v_cvt_pk_bf16_f32 v169, v102, v103
    v_cvt_pk_bf16_f32 v170, v104, v105
    v_cvt_pk_bf16_f32 v171, v106, v107
    v_mfma_f32_32x32x16_bf16 v[92:107], v[52:55], v[68:71], 0
    v_exp_f32 v76, v76
    v_exp_f32 v77, v77
    v_exp_f32 v78, v78
    v_exp_f32 v79, v79
    v_mfma_f32_32x32x16_bf16 v[140:155], v[204:207], v[164:167], v[140:155]
    v_exp_f32 v80, v80
    v_exp_f32 v81, v81
    v_exp_f32 v82, v82
    v_exp_f32 v83, v83
    v_mfma_f32_32x32x16_bf16 v[140:155], v[208:211], v[168:171], v[140:155]
    v_exp_f32 v84, v84
    v_exp_f32 v85, v85
    v_exp_f32 v86, v86
    v_exp_f32 v87, v87
    v_exp_f32 v88, v88
    v_exp_f32 v89, v89
    v_exp_f32 v90, v90
    v_exp_f32 v91, v91
    s_waitcnt vmcnt(5)
    v_permlane16_swap_b32 v212, v216
    v_permlane16_swap_b32 v213, v217
    v_permlane16_swap_b32 v214, v218
    v_permlane16_swap_b32 v215, v219
    v_cvt_pk_bf16_f32 v156, v76, v77
    v_cvt_pk_bf16_f32 v157, v78, v79
    v_cvt_pk_bf16_f32 v158, v80, v81
    v_cvt_pk_bf16_f32 v159, v82, v83
    v_cvt_pk_bf16_f32 v160, v84, v85
    v_cvt_pk_bf16_f32 v161, v86, v87
    v_cvt_pk_bf16_f32 v162, v88, v89
    v_cvt_pk_bf16_f32 v163, v90, v91
    v_mfma_f32_32x32x16_bf16 v[76:91], v[56:59], v[68:71], 0
    v_exp_f32 v92, v92
    v_exp_f32 v93, v93
    v_exp_f32 v94, v94
    v_exp_f32 v95, v95
    v_mfma_f32_32x32x16_bf16 v[140:155], v[212:215], v[156:159], v[140:155]
    v_exp_f32 v96, v96
    v_exp_f32 v97, v97
    v_exp_f32 v98, v98
    v_exp_f32 v99, v99
    v_mfma_f32_32x32x16_bf16 v[140:155], v[216:219], v[160:163], v[140:155]
    v_exp_f32 v100, v100
    v_exp_f32 v101, v101
    v_exp_f32 v102, v102
    v_exp_f32 v103, v103
    v_exp_f32 v104, v104
    v_exp_f32 v105, v105
    v_exp_f32 v106, v106
    v_exp_f32 v107, v107
    s_waitcnt vmcnt(4)
    v_permlane16_swap_b32 v220, v224
    v_permlane16_swap_b32 v221, v225
    v_permlane16_swap_b32 v222, v226
    v_permlane16_swap_b32 v223, v227
    v_cvt_pk_bf16_f32 v164, v92, v93
    v_cvt_pk_bf16_f32 v165, v94, v95
    v_cvt_pk_bf16_f32 v166, v96, v97
    v_cvt_pk_bf16_f32 v167, v98, v99
    v_cvt_pk_bf16_f32 v168, v100, v101
    v_cvt_pk_bf16_f32 v169, v102, v103
    v_cvt_pk_bf16_f32 v170, v104, v105
    v_cvt_pk_bf16_f32 v171, v106, v107
    v_mfma_f32_32x32x16_bf16 v[140:155], v[220:223], v[164:167], v[140:155]
    v_exp_f32 v76, v76
    v_exp_f32 v77, v77
    v_exp_f32 v78, v78
    v_exp_f32 v79, v79
    v_mfma_f32_32x32x16_bf16 v[140:155], v[224:227], v[168:171], v[140:155]
    v_exp_f32 v80, v80
    v_exp_f32 v81, v81
    v_exp_f32 v82, v82
    v_exp_f32 v83, v83
    s_waitcnt vmcnt(2)
    v_mfma_f32_32x32x16_bf16 v[92:107], v[64:67], v[72:75], 0
    v_exp_f32 v84, v84
    v_exp_f32 v85, v85
    v_exp_f32 v86, v86
    v_exp_f32 v87, v87
    v_mfma_f32_32x32x16_bf16 v[108:123], v[32:35], v[72:75], 0
    v_exp_f32 v88, v88
    v_exp_f32 v89, v89
    v_exp_f32 v90, v90
    v_exp_f32 v91, v91
    s_waitcnt vmcnt(1)
    v_permlane16_swap_b32 v228, v232
    v_permlane16_swap_b32 v229, v233
    v_permlane16_swap_b32 v230, v234
    v_permlane16_swap_b32 v231, v235
    v_cvt_pk_bf16_f32 v156, v76, v77
    v_cvt_pk_bf16_f32 v157, v78, v79
    v_cvt_pk_bf16_f32 v158, v80, v81
    v_cvt_pk_bf16_f32 v159, v82, v83
    v_cvt_pk_bf16_f32 v160, v84, v85
    v_cvt_pk_bf16_f32 v161, v86, v87
    v_mfma_f32_32x32x16_bf16 v[140:155], v[228:231], v[156:159], v[140:155]
    v_cvt_pk_bf16_f32 v162, v88, v89
    v_cvt_pk_bf16_f32 v163, v90, v91
    s_nop 1
    v_mfma_f32_32x32x16_bf16 v[140:155], v[232:235], v[160:163], v[140:155]
    s_waitcnt vmcnt(0)
    v_permlane16_swap_b32 v244, v248
    v_permlane16_swap_b32 v245, v249
    v_permlane16_swap_b32 v246, v250
    v_permlane16_swap_b32 v247, v251
    s_nop 6
    v_cmp_gt_f32 vcc, 528482304, v148
    s_nop 0
    s_mov_b64 s[60:61], vcc
    v_cmp_nge_f32 vcc, 1602224128, v148
    s_nop 0
    s_or_b64 vcc, vcc, s[60:61]
    s_nop 2
    s_cbranch_vccnz L_att_gen
    v_rcp_f32 v26, v148
    s_nop 0
    v_mul_f32 v26, v26, v24
    v_mul_f32 v140, v140, v26
    v_mul_f32 v141, v141, v26
    v_mul_f32 v142, v142, v26
    v_mul_f32 v143, v143, v26
    v_mul_f32 v144, v144, v26
    v_mul_f32 v145, v145, v26
    v_mul_f32 v146, v146, v26
    v_mul_f32 v147, v147, v26
    v_cvt_pk_bf16_f32 v124, v140, v141
    v_cvt_pk_bf16_f32 v125, v142, v143
    v_cvt_pk_bf16_f32 v126, v144, v145
    v_cvt_pk_bf16_f32 v127, v146, v147
    v_mfma_f32_32x32x16_bf16 v[76:91], v[36:39], v[72:75], 0
    v_cndmask_b32 v108, v108, v92, s[64:65]
    v_cndmask_b32 v109, v109, v93, s[66:67]
    v_cndmask_b32 v110, v110, v94, s[68:69]
    v_cndmask_b32 v111, v111, v95, s[70:71]
    v_cndmask_b32 v112, v112, v96, s[72:73]
    v_cndmask_b32 v113, v113, v97, s[74:75]
    v_cndmask_b32 v114, v114, v98, s[76:77]
    v_cndmask_b32 v115, v115, v99, s[78:79]
    v_cndmask_b32 v116, v116, v100, s[80:81]
    v_cndmask_b32 v117, v117, v101, s[82:83]
    v_cndmask_b32 v118, v118, v102, s[84:85]
    v_cndmask_b32 v119, v119, v103, s[86:87]
    v_cndmask_b32 v120, v120, v104, s[88:89]
    v_cndmask_b32 v121, v121, v105, s[90:91]
    v_cndmask_b32 v122, v122, v106, s[92:93]
    v_cndmask_b32 v123, v123, v107, s[94:95]
    v_exp_f32 v108, v108
    v_exp_f32 v109, v109
    v_exp_f32 v110, v110
    v_exp_f32 v111, v111
    v_exp_f32 v112, v112
    v_exp_f32 v113, v113
    v_exp_f32 v114, v114
    v_exp_f32 v115, v115
    v_exp_f32 v116, v116
    v_exp_f32 v117, v117
    v_exp_f32 v118, v118
    v_exp_f32 v119, v119
    v_exp_f32 v120, v120
    v_exp_f32 v121, v121
    v_exp_f32 v122, v122
    v_exp_f32 v123, v123
    v_cvt_pk_bf16_f32 v108, v108, v109
    v_cvt_pk_bf16_f32 v109, v110, v111
    v_cvt_pk_bf16_f32 v110, v112, v113
    v_cvt_pk_bf16_f32 v111, v114, v115
    v_cvt_pk_bf16_f32 v112, v116, v117
    v_cvt_pk_bf16_f32 v113, v118, v119
    v_cvt_pk_bf16_f32 v114, v120, v121
    v_cvt_pk_bf16_f32 v115, v122, v123
    v_and_b32 v116, v108, v15
    v_and_b32 v117, v109, v16
    v_and_b32 v118, v110, v17
    v_and_b32 v119, v111, v18
    v_and_b32 v120, v112, v19
    v_and_b32 v121, v113, v20
    v_and_b32 v122, v114, v21
    v_and_b32 v123, v115, v22
    v_xor_b32 v108, v108, v116
    v_xor_b32 v109, v109, v117
    v_xor_b32 v110, v110, v118
    v_xor_b32 v111, v111, v119
    v_xor_b32 v112, v112, v120
    v_xor_b32 v113, v113, v121
    v_xor_b32 v114, v114, v122
    v_xor_b32 v115, v115, v123
    v_mfma_f32_32x32x16_bf16 v[92:107], v[40:43], v[72:75], 0
    v_exp_f32 v76, v76
    v_exp_f32 v77, v77
    v_exp_f32 v78, v78
    v_exp_f32 v79, v79
    v_mfma_f32_32x32x16_bf16 v[140:155], v[180:183], v[108:111], 0
    v_exp_f32 v80, v80
    v_exp_f32 v81, v81
    v_exp_f32 v82, v82
    v_exp_f32 v83, v83
    v_mfma_f32_32x32x16_bf16 v[140:155], v[184:187], v[112:115], v[140:155]
    v_exp_f32 v84, v84
    v_exp_f32 v85, v85
    v_exp_f32 v86, v86
    v_exp_f32 v87, v87
    v_mfma_f32_32x32x16_bf16 v[140:155], v[244:247], v[116:119], v[140:155]
    v_exp_f32 v88, v88
    v_exp_f32 v89, v89
    v_exp_f32 v90, v90
    v_exp_f32 v91, v91
    v_cvt_pk_bf16_f32 v156, v76, v77
    v_cvt_pk_bf16_f32 v157, v78, v79
    v_cvt_pk_bf16_f32 v158, v80, v81
    v_cvt_pk_bf16_f32 v159, v82, v83
    v_cvt_pk_bf16_f32 v160, v84, v85
    v_cvt_pk_bf16_f32 v161, v86, v87
    v_cvt_pk_bf16_f32 v162, v88, v89
    v_cvt_pk_bf16_f32 v163, v90, v91
    v_mfma_f32_32x32x16_bf16 v[76:91], v[44:47], v[72:75], 0
    v_exp_f32 v92, v92
    v_exp_f32 v93, v93
    v_exp_f32 v94, v94
    v_exp_f32 v95, v95
    v_mfma_f32_32x32x16_bf16 v[140:155], v[248:251], v[120:123], v[140:155]
    v_exp_f32 v96, v96
    v_exp_f32 v97, v97
    v_exp_f32 v98, v98
    v_exp_f32 v99, v99
    v_mfma_f32_32x32x16_bf16 v[140:155], v[188:191], v[156:159], v[140:155]
    v_exp_f32 v100, v100
    v_exp_f32 v101, v101
    v_exp_f32 v102, v102
    v_exp_f32 v103, v103
    v_mfma_f32_32x32x16_bf16 v[140:155], v[192:195], v[160:163], v[140:155]
    v_exp_f32 v104, v104
    v_exp_f32 v105, v105
    v_exp_f32 v106, v106
    v_exp_f32 v107, v107
    v_cvt_pk_bf16_f32 v164, v92, v93
    v_cvt_pk_bf16_f32 v165, v94, v95
    v_cvt_pk_bf16_f32 v166, v96, v97
    v_cvt_pk_bf16_f32 v167, v98, v99
    v_cvt_pk_bf16_f32 v168, v100, v101
    v_cvt_pk_bf16_f32 v169, v102, v103
    v_cvt_pk_bf16_f32 v170, v104, v105
    v_cvt_pk_bf16_f32 v171, v106, v107
    v_mfma_f32_32x32x16_bf16 v[92:107], v[48:51], v[72:75], 0
    v_exp_f32 v76, v76
    v_exp_f32 v77, v77
    v_exp_f32 v78, v78
    v_exp_f32 v79, v79
    v_mfma_f32_32x32x16_bf16 v[140:155], v[196:199], v[164:167], v[140:155]
    v_exp_f32 v80, v80
    v_exp_f32 v81, v81
    v_exp_f32 v82, v82
    v_exp_f32 v83, v83
    v_mfma_f32_32x32x16_bf16 v[140:155], v[200:203], v[168:171], v[140:155]
    v_exp_f32 v84, v84
    v_exp_f32 v85, v85
    v_exp_f32 v86, v86
    v_exp_f32 v87, v87
    v_exp_f32 v88, v88
    v_exp_f32 v89, v89
    v_exp_f32 v90, v90
    v_exp_f32 v91, v91
    v_cvt_pk_bf16_f32 v156, v76, v77
    v_cvt_pk_bf16_f32 v157, v78, v79
    v_cvt_pk_bf16_f32 v158, v80, v81
    v_cvt_pk_bf16_f32 v159, v82, v83
    v_cvt_pk_bf16_f32 v160, v84, v85
    v_cvt_pk_bf16_f32 v161, v86, v87
    v_cvt_pk_bf16_f32 v162, v88, v89
    v_cvt_pk_bf16_f32 v163, v90, v91
    v_mfma_f32_32x32x16_bf16 v[76:91], v[52:55], v[72:75], 0
    v_exp_f32 v92, v92
    v_exp_f32 v93, v93
    v_exp_f32 v94, v94
    v_exp_f32 v95, v95
    v_mfma_f32_32x32x16_bf16 v[140:155], v[204:207], v[156:159], v[140:155]
    v_exp_f32 v96, v96
    v_exp_f32 v97, v97
    v_exp_f32 v98, v98
    v_exp_f32 v99, v99
    v_mfma_f32_32x32x16_bf16 v[140:155], v[208:211], v[160:163], v[140:155]
    v_exp_f32 v100, v100
    v_exp_f32 v101, v101
    v_exp_f32 v102, v102
    v_exp_f32 v103, v103
    v_exp_f32 v104, v104
    v_exp_f32 v105, v105
    v_exp_f32 v106, v106
    v_exp_f32 v107, v107
    v_cvt_pk_bf16_f32 v164, v92, v93
    v_cvt_pk_bf16_f32 v165, v94, v95
    v_cvt_pk_bf16_f32 v166, v96, v97
    v_cvt_pk_bf16_f32 v167, v98, v99
    v_cvt_pk_bf16_f32 v168, v100, v101
    v_cvt_pk_bf16_f32 v169, v102, v103
    v_cvt_pk_bf16_f32 v170, v104, v105
    v_cvt_pk_bf16_f32 v171, v106, v107
    v_mfma_f32_32x32x16_bf16 v[92:107], v[56:59], v[72:75], 0
    v_exp_f32 v76, v76
    v_exp_f32 v77, v77
    v_exp_f32 v78, v78
    v_exp_f32 v79, v79
    v_mfma_f32_32x32x16_bf16 v[140:155], v[212:215], v[164:167], v[140:155]
    v_exp_f32 v80, v80
    v_exp_f32 v81, v81
    v_exp_f32 v82, v82
    v_exp_f32 v83, v83
    v_mfma_f32_32x32x16_bf16 v[140:155], v[216:219], v[168:171], v[140:155]
    v_exp_f32 v84, v84
    v_exp_f32 v85, v85
    v_exp_f32 v86, v86
    v_exp_f32 v87, v87
    v_exp_f32 v88, v88
    v_exp_f32 v89, v89
    v_exp_f32 v90, v90
    v_exp_f32 v91, v91
    v_cvt_pk_bf16_f32 v156, v76, v77
    v_cvt_pk_bf16_f32 v157, v78, v79
    v_cvt_pk_bf16_f32 v158, v80, v81
    v_cvt_pk_bf16_f32 v159, v82, v83
    v_cvt_pk_bf16_f32 v160, v84, v85
    v_cvt_pk_bf16_f32 v161, v86, v87
    v_cvt_pk_bf16_f32 v162, v88, v89
    v_cvt_pk_bf16_f32 v163, v90, v91
    v_mfma_f32_32x32x16_bf16 v[76:91], v[60:63], v[72:75], 0
    v_exp_f32 v92, v92
    v_exp_f32 v93, v93
    v_exp_f32 v94, v94
    v_exp_f32 v95, v95
    v_mfma_f32_32x32x16_bf16 v[140:155], v[220:223], v[156:159], v[140:155]
    v_exp_f32 v96, v96
    v_exp_f32 v97, v97
    v_exp_f32 v98, v98
    v_exp_f32 v99, v99
    v_mfma_f32_32x32x16_bf16 v[140:155], v[224:227], v[160:163], v[140:155]
    v_exp_f32 v100, v100
    v_exp_f32 v101, v101
    v_exp_f32 v102, v102
    v_exp_f32 v103, v103
    v_exp_f32 v104, v104
    v_exp_f32 v105, v105
    v_exp_f32 v106, v106
    v_exp_f32 v107, v107
    v_cvt_pk_bf16_f32 v164, v92, v93
    v_cvt_pk_bf16_f32 v165, v94, v95
    v_cvt_pk_bf16_f32 v166, v96, v97
    v_cvt_pk_bf16_f32 v167, v98, v99
    v_cvt_pk_bf16_f32 v168, v100, v101
    v_cvt_pk_bf16_f32 v169, v102, v103
    v_cvt_pk_bf16_f32 v170, v104, v105
    v_cvt_pk_bf16_f32 v171, v106, v107
    v_mfma_f32_32x32x16_bf16 v[140:155], v[228:231], v[164:167], v[140:155]
    v_exp_f32 v76, v76
    v_exp_f32 v77, v77
    v_exp_f32 v78, v78
    v_exp_f32 v79, v79
    v_mfma_f32_32x32x16_bf16 v[140:155], v[232:235], v[168:171], v[140:155]
    v_exp_f32 v80, v80
    v_exp_f32 v81, v81
    v_exp_f32 v82, v82
    v_exp_f32 v83, v83
    v_exp_f32 v84, v84
    v_exp_f32 v85, v85
    v_exp_f32 v86, v86
    v_exp_f32 v87, v87
    v_exp_f32 v88, v88
    v_exp_f32 v89, v89
    v_exp_f32 v90, v90
    v_exp_f32 v91, v91
    v_cvt_pk_bf16_f32 v156, v76, v77
    v_cvt_pk_bf16_f32 v157, v78, v79
    v_cvt_pk_bf16_f32 v158, v80, v81
    v_cvt_pk_bf16_f32 v159, v82, v83
    v_cvt_pk_bf16_f32 v160, v84, v85
    v_cvt_pk_bf16_f32 v161, v86, v87
    v_mfma_f32_32x32x16_bf16 v[140:155], v[236:239], v[156:159], v[140:155]
    v_cvt_pk_bf16_f32 v162, v88, v89
    v_cvt_pk_bf16_f32 v163, v90, v91
    s_nop 1
    v_mfma_f32_32x32x16_bf16 v[140:155], v[240:243], v[160:163], v[140:155]
    s_nop 11
    v_cmp_gt_f32 vcc, 528482304, v148
    s_nop 0
    s_mov_b64 s[60:61], vcc
    v_cmp_nge_f32 vcc, 1602224128, v148
    s_nop 0
    s_or_b64 vcc, vcc, s[60:61]
    s_nop 2
    s_cbranch_vccnz L_att_gen
    s_add_u32 s59, s57, 0
    s_mul_i32 s59, s59, 144
    s_add_u32 s59, s59, s56
    s_add_u32 s59, s59, 112
    s_lshl_b32 s59, s59, 10
    s_add_u32 s59, s59, 8388608
    buffer_store_dwordx4 v[124:127], v2, s[36:39], s59 offen sc1
    v_rcp_f32 v26, v148
    s_nop 0
    v_mul_f32 v26, v26, v25
    v_mul_f32 v140, v140, v26
    v_mul_f32 v141, v141, v26
    v_mul_f32 v142, v142, v26
    v_mul_f32 v143, v143, v26
    v_mul_f32 v144, v144, v26
    v_mul_f32 v145, v145, v26
    v_mul_f32 v146, v146, v26
    v_mul_f32 v147, v147, v26
    v_cvt_pk_bf16_f32 v128, v140, v141
    v_cvt_pk_bf16_f32 v129, v142, v143
    v_cvt_pk_bf16_f32 v130, v144, v145
    v_cvt_pk_bf16_f32 v131, v146, v147
    s_add_u32 s59, s57, 1
    s_mul_i32 s59, s59, 144
    s_add_u32 s59, s59, s56
    s_add_u32 s59, s59, 112
    s_lshl_b32 s59, s59, 10
    s_add_u32 s59, s59, 8388608
    buffer_store_dwordx4 v[128:131], v2, s[36:39], s59 offen sc1
L_att_pub:
    s_waitcnt vmcnt(0)
    s_sub_u32 s60, s58, s101
    s_sub_u32 s60, s60, 3
    s_cmp_eq_u32 s53, 0
    s_cselect_b32 s101, s60, 1
    s_add_u32 s59, s3, 131072
    s_atomic_add s101, s[26:27], s59
    s_endpgm
L_att_gen:
    s_nop 15
    s_waitcnt vmcnt(0) lgkmcnt(0)
    v_mfma_f32_32x32x16_bf16 v[76:91], v[60:63], v[68:71], 0
    v_mov_b32 v92, 0xff800000
    v_mov_b32 v93, 0xff800000
    v_mov_b32 v94, 0xff800000
    v_mov_b32 v95, 0xff800000
    v_mov_b32 v96, 0xff800000
    v_mov_b32 v97, 0xff800000
    v_mov_b32 v98, 0xff800000
    v_mov_b32 v99, 0xff800000
    v_mov_b32 v100, 0xff800000
    v_mov_b32 v101, 0xff800000
    v_mov_b32 v102, 0xff800000
    v_mov_b32 v103, 0xff800000
    v_mov_b32 v104, 0xff800000
    v_mov_b32 v105, 0xff800000
    v_mov_b32 v106, 0xff800000
    v_mov_b32 v107, 0xff800000
    s_nop 1
    s_cmp_gt_u32 s98, 0
    s_cbranch_scc1 L_sk_27
    v_mfma_f32_32x32x16_bf16 v[92:107], v[28:31], v[68:71], 0
    s_nop 11
L_sk_27:
    v_cndmask_b32 v108, v92, v76, s[64:65]
    v_cndmask_b32 v109, v93, v77, s[66:67]
    v_cndmask_b32 v110, v94, v78, s[68:69]
    v_cndmask_b32 v111, v95, v79, s[70:71]
    v_cndmask_b32 v112, v96, v80, s[72:73]
    v_cndmask_b32 v113, v97, v81, s[74:75]
    v_cndmask_b32 v114, v98, v82, s[76:77]
    v_cndmask_b32 v115, v99, v83, s[78:79]
    v_cndmask_b32 v116, v100, v84, s[80:81]
    v_cndmask_b32 v117, v101, v85, s[82:83]
    v_cndmask_b32 v118, v102, v86, s[84:85]
    v_cndmask_b32 v119, v103, v87, s[86:87]
    v_cndmask_b32 v120, v104, v88, s[88:89]
    v_cndmask_b32 v121, v105, v89, s[90:91]
    v_cndmask_b32 v122, v106, v90, s[92:93]
    v_cndmask_b32 v123, v107, v91, s[94:95]
    v_max_f32 v26, v108, v109
    v_max_f32 v27, v110, v111
    v_max3_f32 v26, v26, v112, v113
    v_max3_f32 v27, v27, v114, v115
    v_max3_f32 v26, v26, v116, v117
    v_max3_f32 v27, v27, v118, v119
    v_max3_f32 v26, v26, v120, v121
    v_max3_f32 v27, v27, v122, v123
    s_nop 1
    s_cmp_gt_u32 s98, 1
    s_cbranch_scc1 L_sk_28
    v_mfma_f32_32x32x16_bf16 v[76:91], v[32:35], v[68:71], 0
    s_nop 11
    v_max3_f32 v26, v26, v76, v77
    v_max3_f32 v27, v27, v78, v79
    v_max3_f32 v26, v26, v80, v81
    v_max3_f32 v27, v27, v82, v83
    v_max3_f32 v26, v26, v84, v85
    v_max3_f32 v27, v27, v86, v87
    v_max3_f32 v26, v26, v88, v89
    v_max3_f32 v27, v27, v90, v91
    s_nop 1
L_sk_28:
    s_cmp_gt_u32 s98, 2
    s_cbranch_scc1 L_sk_29
    v_mfma_f32_32x32x16_bf16 v[92:107], v[36:39], v[68:71], 0
    s_nop 11
    v_max3_f32 v26, v26, v92, v93
    v_max3_f32 v27, v27, v94, v95
    v_max3_f32 v26, v26, v96, v97
    v_max3_f32 v27, v27, v98, v99
    v_max3_f32 v26, v26, v100, v101
    v_max3_f32 v27, v27, v102, v103
    v_max3_f32 v26, v26, v104, v105
    v_max3_f32 v27, v27, v106, v107
    s_nop 1
L_sk_29:
    s_cmp_gt_u32 s98, 3
    s_cbranch_scc1 L_sk_30
    v_mfma_f32_32x32x16_bf16 v[76:91], v[40:43], v[68:71], 0
    s_nop 11
    v_max3_f32 v26, v26, v76, v77
    v_max3_f32 v27, v27, v78, v79
    v_max3_f32 v26, v26, v80, v81
    v_max3_f32 v27, v27, v82, v83
    v_max3_f32 v26, v26, v84, v85
    v_max3_f32 v27, v27, v86, v87
    v_max3_f32 v26, v26, v88, v89
    v_max3_f32 v27, v27, v90, v91
    s_nop 1
L_sk_30:
    s_cmp_gt_u32 s98, 4
    s_cbranch_scc1 L_sk_31
    v_mfma_f32_32x32x16_bf16 v[92:107], v[44:47], v[68:71], 0
    s_nop 11
    v_max3_f32 v26, v26, v92, v93
    v_max3_f32 v27, v27, v94, v95
    v_max3_f32 v26, v26, v96, v97
    v_max3_f32 v27, v27, v98, v99
    v_max3_f32 v26, v26, v100, v101
    v_max3_f32 v27, v27, v102, v103
    v_max3_f32 v26, v26, v104, v105
    v_max3_f32 v27, v27, v106, v107
    s_nop 1
L_sk_31:
    s_cmp_gt_u32 s98, 5
    s_cbranch_scc1 L_sk_32
    v_mfma_f32_32x32x16_bf16 v[76:91], v[48:51], v[68:71], 0
    s_nop 11
    v_max3_f32 v26, v26, v76, v77
    v_max3_f32 v27, v27, v78, v79
    v_max3_f32 v26, v26, v80, v81
    v_max3_f32 v27, v27, v82, v83
    v_max3_f32 v26, v26, v84, v85
    v_max3_f32 v27, v27, v86, v87
    v_max3_f32 v26, v26, v88, v89
    v_max3_f32 v27, v27, v90, v91
    s_nop 1
L_sk_32:
    s_cmp_gt_u32 s98, 6
    s_cbranch_scc1 L_sk_33
    v_mfma_f32_32x32x16_bf16 v[92:107], v[52:55], v[68:71], 0
    s_nop 11
    v_max3_f32 v26, v26, v92, v93
    v_max3_f32 v27, v27, v94, v95
    v_max3_f32 v26, v26, v96, v97
    v_max3_f32 v27, v27, v98, v99
    v_max3_f32 v26, v26, v100, v101
    v_max3_f32 v27, v27, v102, v103
    v_max3_f32 v26, v26, v104, v105
    v_max3_f32 v27, v27, v106, v107
    s_nop 1
L_sk_33:
    s_cmp_gt_u32 s98, 7
    s_cbranch_scc1 L_sk_34
    v_mfma_f32_32x32x16_bf16 v[76:91], v[56:59], v[68:71], 0
    s_nop 11
    v_max3_f32 v26, v26, v76, v77
    v_max3_f32 v27, v27, v78, v79
    v_max3_f32 v26, v26, v80, v81
    v_max3_f32 v27, v27, v82, v83
    v_max3_f32 v26, v26, v84, v85
    v_max3_f32 v27, v27, v86, v87
    v_max3_f32 v26, v26, v88, v89
    v_max3_f32 v27, v27, v90, v91
    s_nop 1
L_sk_34:
    v_max_f32 v26, v26, v27
    v_mov_b32 v27, v26
    s_nop 1
    v_permlane32_swap_b32 v26, v27
    v_max_f32 v26, v26, v27
    v_sub_f32 v124, 0, v26
    v_sub_f32 v125, 0, v26
    v_sub_f32 v126, 0, v26
    v_sub_f32 v127, 0, v26
    v_sub_f32 v128, 0, v26
    v_sub_f32 v129, 0, v26
    v_sub_f32 v130, 0, v26
    v_sub_f32 v131, 0, v26
    v_sub_f32 v132, 0, v26
    v_sub_f32 v133, 0, v26
    v_sub_f32 v134, 0, v26
    v_sub_f32 v135, 0, v26
    v_sub_f32 v136, 0, v26
    v_sub_f32 v137, 0, v26
    v_sub_f32 v138, 0, v26
    v_sub_f32 v139, 0, v26
    v_add_f32 v108, v108, v124
    v_add_f32 v109, v109, v124
    v_add_f32 v110, v110, v124
    v_add_f32 v111, v111, v124
    v_add_f32 v112, v112, v124
    v_add_f32 v113, v113, v124
    v_add_f32 v114, v114, v124
    v_add_f32 v115, v115, v124
    v_add_f32 v116, v116, v124
    v_add_f32 v117, v117, v124
    v_add_f32 v118, v118, v124
    v_add_f32 v119, v119, v124
    v_add_f32 v120, v120, v124
    v_add_f32 v121, v121, v124
    v_add_f32 v122, v122, v124
    v_add_f32 v123, v123, v124
    v_exp_f32 v108, v108
    v_exp_f32 v109, v109
    v_exp_f32 v110, v110
    v_exp_f32 v111, v111
    v_exp_f32 v112, v112
    v_exp_f32 v113, v113
    v_exp_f32 v114, v114
    v_exp_f32 v115, v115
    v_exp_f32 v116, v116
    v_exp_f32 v117, v117
    v_exp_f32 v118, v118
    v_exp_f32 v119, v119
    v_exp_f32 v120, v120
    v_exp_f32 v121, v121
    v_exp_f32 v122, v122
    v_exp_f32 v123, v123
    v_cvt_pk_bf16_f32 v108, v108, v109
    v_cvt_pk_bf16_f32 v109, v110, v111
    v_cvt_pk_bf16_f32 v110, v112, v113
    v_cvt_pk_bf16_f32 v111, v114, v115
    v_cvt_pk_bf16_f32 v112, v116, v117
    v_cvt_pk_bf16_f32 v113, v118, v119
    v_cvt_pk_bf16_f32 v114, v120, v121
    v_cvt_pk_bf16_f32 v115, v122, v123
    v_and_b32 v116, v108, v15
    v_and_b32 v117, v109, v16
    v_and_b32 v118, v110, v17
    v_and_b32 v119, v111, v18
    v_and_b32 v120, v112, v19
    v_and_b32 v121, v113, v20
    v_and_b32 v122, v114, v21
    v_and_b32 v123, v115, v22
    v_xor_b32 v108, v108, v116
    v_xor_b32 v109, v109, v117
    v_xor_b32 v110, v110, v118
    v_xor_b32 v111, v111, v119
    v_xor_b32 v112, v112, v120
    v_xor_b32 v113, v113, v121
    v_xor_b32 v114, v114, v122
    v_xor_b32 v115, v115, v123
    v_mfma_f32_32x32x16_bf16 v[140:155], v[236:239], v[116:119], 0
    v_mfma_f32_32x32x16_bf16 v[140:155], v[240:243], v[120:123], v[140:155]
    s_nop 11
    s_cmp_gt_u32 s98, 0
    s_cbranch_scc1 L_sk_35
    v_mfma_f32_32x32x16_bf16 v[140:155], v[172:175], v[108:111], v[140:155]
    v_mfma_f32_32x32x16_bf16 v[140:155], v[176:179], v[112:115], v[140:155]
    s_nop 11
L_sk_35:
    s_cmp_gt_u32 s98, 1
    s_cbranch_scc1 L_sk_36
    v_mfma_f32_32x32x16_bf16 v[76:91], v[32:35], v[68:71], v[124:139]
    s_nop 11
    v_exp_f32 v76, v76
    v_exp_f32 v77, v77
    v_exp_f32 v78, v78
    v_exp_f32 v79, v79
    v_exp_f32 v80, v80
    v_exp_f32 v81, v81
    v_exp_f32 v82, v82
    v_exp_f32 v83, v83
    v_exp_f32 v84, v84
    v_exp_f32 v85, v85
    v_exp_f32 v86, v86
    v_exp_f32 v87, v87
    v_exp_f32 v88, v88
    v_exp_f32 v89, v89
    v_exp_f32 v90, v90
    v_exp_f32 v91, v91
    v_cvt_pk_bf16_f32 v156, v76, v77
    v_cvt_pk_bf16_f32 v157, v78, v79
    v_cvt_pk_bf16_f32 v158, v80, v81
    v_cvt_pk_bf16_f32 v159, v82, v83
    v_cvt_pk_bf16_f32 v160, v84, v85
    v_cvt_pk_bf16_f32 v161, v86, v87
    v_cvt_pk_bf16_f32 v162, v88, v89
    v_cvt_pk_bf16_f32 v163, v90, v91
    v_mfma_f32_32x32x16_bf16 v[140:155], v[180:183], v[156:159], v[140:155]
    s_nop 0
    v_mfma_f32_32x32x16_bf16 v[140:155], v[184:187], v[160:163], v[140:155]
    s_nop 11
L_sk_36:
    s_cmp_gt_u32 s98, 2
    s_cbranch_scc1 L_sk_37
    v_mfma_f32_32x32x16_bf16 v[92:107], v[36:39], v[68:71], v[124:139]
    s_nop 11
    v_exp_f32 v92, v92
    v_exp_f32 v93, v93
    v_exp_f32 v94, v94
    v_exp_f32 v95, v95
    v_exp_f32 v96, v96
    v_exp_f32 v97, v97
    v_exp_f32 v98, v98
    v_exp_f32 v99, v99
    v_exp_f32 v100, v100
    v_exp_f32 v101, v101
    v_exp_f32 v102, v102
    v_exp_f32 v103, v103
    v_exp_f32 v104, v104
    v_exp_f32 v105, v105
    v_exp_f32 v106, v106
    v_exp_f32 v107, v107
    v_cvt_pk_bf16_f32 v164, v92, v93
    v_cvt_pk_bf16_f32 v165, v94, v95
    v_cvt_pk_bf16_f32 v166, v96, v97
    v_cvt_pk_bf16_f32 v167, v98, v99
    v_cvt_pk_bf16_f32 v168, v100, v101
    v_cvt_pk_bf16_f32 v169, v102, v103
    v_cvt_pk_bf16_f32 v170, v104, v105
    v_cvt_pk_bf16_f32 v171, v106, v107
    v_mfma_f32_32x32x16_bf16 v[140:155], v[188:191], v[164:167], v[140:155]
    s_nop 0
    v_mfma_f32_32x32x16_bf16 v[140:155], v[192:195], v[168:171], v[140:155]
    s_nop 11
L_sk_37:
    s_cmp_gt_u32 s98, 3
    s_cbranch_scc1 L_sk_38
    v_mfma_f32_32x32x16_bf16 v[76:91], v[40:43], v[68:71], v[124:139]
    s_nop 11
    v_exp_f32 v76, v76
    v_exp_f32 v77, v77
    v_exp_f32 v78, v78
    v_exp_f32 v79, v79
    v_exp_f32 v80, v80
    v_exp_f32 v81, v81
    v_exp_f32 v82, v82
    v_exp_f32 v83, v83
    v_exp_f32 v84, v84
    v_exp_f32 v85, v85
    v_exp_f32 v86, v86
    v_exp_f32 v87, v87
    v_exp_f32 v88, v88
    v_exp_f32 v89, v89
    v_exp_f32 v90, v90
    v_exp_f32 v91, v91
    v_cvt_pk_bf16_f32 v156, v76, v77
    v_cvt_pk_bf16_f32 v157, v78, v79
    v_cvt_pk_bf16_f32 v158, v80, v81
    v_cvt_pk_bf16_f32 v159, v82, v83
    v_cvt_pk_bf16_f32 v160, v84, v85
    v_cvt_pk_bf16_f32 v161, v86, v87
    v_cvt_pk_bf16_f32 v162, v88, v89
    v_cvt_pk_bf16_f32 v163, v90, v91
    v_mfma_f32_32x32x16_bf16 v[140:155], v[196:199], v[156:159], v[140:155]
    s_nop 0
    v_mfma_f32_32x32x16_bf16 v[140:155], v[200:203], v[160:163], v[140:155]
    s_nop 11
L_sk_38:
    s_cmp_gt_u32 s98, 4
    s_cbranch_scc1 L_sk_39
    v_mfma_f32_32x32x16_bf16 v[92:107], v[44:47], v[68:71], v[124:139]
    s_nop 11
    v_exp_f32 v92, v92
    v_exp_f32 v93, v93
    v_exp_f32 v94, v94
    v_exp_f32 v95, v95
    v_exp_f32 v96, v96
    v_exp_f32 v97, v97
    v_exp_f32 v98, v98
    v_exp_f32 v99, v99
    v_exp_f32 v100, v100
    v_exp_f32 v101, v101
    v_exp_f32 v102, v102
    v_exp_f32 v103, v103
    v_exp_f32 v104, v104
    v_exp_f32 v105, v105
    v_exp_f32 v106, v106
    v_exp_f32 v107, v107
    v_cvt_pk_bf16_f32 v164, v92, v93
    v_cvt_pk_bf16_f32 v165, v94, v95
    v_cvt_pk_bf16_f32 v166, v96, v97
    v_cvt_pk_bf16_f32 v167, v98, v99
    v_cvt_pk_bf16_f32 v168, v100, v101
    v_cvt_pk_bf16_f32 v169, v102, v103
    v_cvt_pk_bf16_f32 v170, v104, v105
    v_cvt_pk_bf16_f32 v171, v106, v107
    v_mfma_f32_32x32x16_bf16 v[140:155], v[204:207], v[164:167], v[140:155]
    s_nop 0
    v_mfma_f32_32x32x16_bf16 v[140:155], v[208:211], v[168:171], v[140:155]
    s_nop 11
L_sk_39:
    s_cmp_gt_u32 s98, 5
    s_cbranch_scc1 L_sk_40
    v_mfma_f32_32x32x16_bf16 v[76:91], v[48:51], v[68:71], v[124:139]
    s_nop 11
    v_exp_f32 v76, v76
    v_exp_f32 v77, v77
    v_exp_f32 v78, v78
    v_exp_f32 v79, v79
    v_exp_f32 v80, v80
    v_exp_f32 v81, v81
    v_exp_f32 v82, v82
    v_exp_f32 v83, v83
    v_exp_f32 v84, v84
    v_exp_f32 v85, v85
    v_exp_f32 v86, v86
    v_exp_f32 v87, v87
    v_exp_f32 v88, v88
    v_exp_f32 v89, v89
    v_exp_f32 v90, v90
    v_exp_f32 v91, v91
    v_cvt_pk_bf16_f32 v156, v76, v77
    v_cvt_pk_bf16_f32 v157, v78, v79
    v_cvt_pk_bf16_f32 v158, v80, v81
    v_cvt_pk_bf16_f32 v159, v82, v83
    v_cvt_pk_bf16_f32 v160, v84, v85
    v_cvt_pk_bf16_f32 v161, v86, v87
    v_cvt_pk_bf16_f32 v162, v88, v89
    v_cvt_pk_bf16_f32 v163, v90, v91
    v_mfma_f32_32x32x16_bf16 v[140:155], v[212:215], v[156:159], v[140:155]
    s_nop 0
    v_mfma_f32_32x32x16_bf16 v[140:155], v[216:219], v[160:163], v[140:155]
    s_nop 11
L_sk_40:
    s_cmp_gt_u32 s98, 6
    s_cbranch_scc1 L_sk_41
    v_mfma_f32_32x32x16_bf16 v[92:107], v[52:55], v[68:71], v[124:139]
    s_nop 11
    v_exp_f32 v92, v92
    v_exp_f32 v93, v93
    v_exp_f32 v94, v94
    v_exp_f32 v95, v95
    v_exp_f32 v96, v96
    v_exp_f32 v97, v97
    v_exp_f32 v98, v98
    v_exp_f32 v99, v99
    v_exp_f32 v100, v100
    v_exp_f32 v101, v101
    v_exp_f32 v102, v102
    v_exp_f32 v103, v103
    v_exp_f32 v104, v104
    v_exp_f32 v105, v105
    v_exp_f32 v106, v106
    v_exp_f32 v107, v107
    v_cvt_pk_bf16_f32 v164, v92, v93
    v_cvt_pk_bf16_f32 v165, v94, v95
    v_cvt_pk_bf16_f32 v166, v96, v97
    v_cvt_pk_bf16_f32 v167, v98, v99
    v_cvt_pk_bf16_f32 v168, v100, v101
    v_cvt_pk_bf16_f32 v169, v102, v103
    v_cvt_pk_bf16_f32 v170, v104, v105
    v_cvt_pk_bf16_f32 v171, v106, v107
    v_mfma_f32_32x32x16_bf16 v[140:155], v[220:223], v[164:167], v[140:155]
    s_nop 0
    v_mfma_f32_32x32x16_bf16 v[140:155], v[224:227], v[168:171], v[140:155]
    s_nop 11
L_sk_41:
    s_cmp_gt_u32 s98, 7
    s_cbranch_scc1 L_sk_42
    v_mfma_f32_32x32x16_bf16 v[76:91], v[56:59], v[68:71], v[124:139]
    s_nop 11
    v_exp_f32 v76, v76
    v_exp_f32 v77, v77
    v_exp_f32 v78, v78
    v_exp_f32 v79, v79
    v_exp_f32 v80, v80
    v_exp_f32 v81, v81
    v_exp_f32 v82, v82
    v_exp_f32 v83, v83
    v_exp_f32 v84, v84
    v_exp_f32 v85, v85
    v_exp_f32 v86, v86
    v_exp_f32 v87, v87
    v_exp_f32 v88, v88
    v_exp_f32 v89, v89
    v_exp_f32 v90, v90
    v_exp_f32 v91, v91
    v_cvt_pk_bf16_f32 v156, v76, v77
    v_cvt_pk_bf16_f32 v157, v78, v79
    v_cvt_pk_bf16_f32 v158, v80, v81
    v_cvt_pk_bf16_f32 v159, v82, v83
    v_cvt_pk_bf16_f32 v160, v84, v85
    v_cvt_pk_bf16_f32 v161, v86, v87
    v_cvt_pk_bf16_f32 v162, v88, v89
    v_cvt_pk_bf16_f32 v163, v90, v91
    v_mfma_f32_32x32x16_bf16 v[140:155], v[228:231], v[156:159], v[140:155]
    s_nop 0
    v_mfma_f32_32x32x16_bf16 v[140:155], v[232:235], v[160:163], v[140:155]
    s_nop 11
L_sk_42:
    v_rcp_f32 v26, v148
    s_nop 0
    v_mul_f32 v26, v26, v24
    v_mul_f32 v140, v140, v26
    v_mul_f32 v141, v141, v26
    v_mul_f32 v142, v142, v26
    v_mul_f32 v143, v143, v26
    v_mul_f32 v144, v144, v26
    v_mul_f32 v145, v145, v26
    v_mul_f32 v146, v146, v26
    v_mul_f32 v147, v147, v26
    v_cvt_pk_bf16_f32 v124, v140, v141
    v_cvt_pk_bf16_f32 v125, v142, v143
    v_cvt_pk_bf16_f32 v126, v144, v145
    v_cvt_pk_bf16_f32 v127, v146, v147
    s_add_u32 s59, s57, 0
    s_mul_i32 s59, s59, 144
    s_add_u32 s59, s59, s56
    s_add_u32 s59, s59, 112
    s_lshl_b32 s59, s59, 10
    s_add_u32 s59, s59, 8388608
    buffer_store_dwordx4 v[124:127], v2, s[36:39], s59 offen sc1
    v_mfma_f32_32x32x16_bf16 v[76:91], v[64:67], v[72:75], 0
    v_mov_b32 v92, 0xff800000
    v_mov_b32 v93, 0xff800000
    v_mov_b32 v94, 0xff800000
    v_mov_b32 v95, 0xff800000
    v_mov_b32 v96, 0xff800000
    v_mov_b32 v97, 0xff800000
    v_mov_b32 v98, 0xff800000
    v_mov_b32 v99, 0xff800000
    v_mov_b32 v100, 0xff800000
    v_mov_b32 v101, 0xff800000
    v_mov_b32 v102, 0xff800000
    v_mov_b32 v103, 0xff800000
    v_mov_b32 v104, 0xff800000
    v_mov_b32 v105, 0xff800000
    v_mov_b32 v106, 0xff800000
    v_mov_b32 v107, 0xff800000
    s_nop 1
    s_cmp_gt_u32 s98, 1
    s_cbranch_scc1 L_sk_43
    v_mfma_f32_32x32x16_bf16 v[92:107], v[32:35], v[72:75], 0
    s_nop 11
L_sk_43:
    v_cndmask_b32 v108, v92, v76, s[64:65]
    v_cndmask_b32 v109, v93, v77, s[66:67]
    v_cndmask_b32 v110, v94, v78, s[68:69]
    v_cndmask_b32 v111, v95, v79, s[70:71]
    v_cndmask_b32 v112, v96, v80, s[72:73]
    v_cndmask_b32 v113, v97, v81, s[74:75]
    v_cndmask_b32 v114, v98, v82, s[76:77]
    v_cndmask_b32 v115, v99, v83, s[78:79]
    v_cndmask_b32 v116, v100, v84, s[80:81]
    v_cndmask_b32 v117, v101, v85, s[82:83]
    v_cndmask_b32 v118, v102, v86, s[84:85]
    v_cndmask_b32 v119, v103, v87, s[86:87]
    v_cndmask_b32 v120, v104, v88, s[88:89]
    v_cndmask_b32 v121, v105, v89, s[90:91]
    v_cndmask_b32 v122, v106, v90, s[92:93]
    v_cndmask_b32 v123, v107, v91, s[94:95]
    v_max_f32 v26, v108, v109
    v_max_f32 v27, v110, v111
    v_max3_f32 v26, v26, v112, v113
    v_max3_f32 v27, v27, v114, v115
    v_max3_f32 v26, v26, v116, v117
    v_max3_f32 v27, v27, v118, v119
    v_max3_f32 v26, v26, v120, v121
    v_max3_f32 v27, v27, v122, v123
    s_nop 1
    s_cmp_gt_u32 s98, 2
    s_cbranch_scc1 L_sk_44
    v_mfma_f32_32x32x16_bf16 v[76:91], v[36:39], v[72:75], 0
    s_nop 11
    v_max3_f32 v26, v26, v76, v77
    v_max3_f32 v27, v27, v78, v79
    v_max3_f32 v26, v26, v80, v81
    v_max3_f32 v27, v27, v82, v83
    v_max3_f32 v26, v26, v84, v85
    v_max3_f32 v27, v27, v86, v87
    v_max3_f32 v26, v26, v88, v89
    v_max3_f32 v27, v27, v90, v91
    s_nop 1
L_sk_44:
    s_cmp_gt_u32 s98, 3
    s_cbranch_scc1 L_sk_45
    v_mfma_f32_32x32x16_bf16 v[92:107], v[40:43], v[72:75], 0
    s_nop 11
    v_max3_f32 v26, v26, v92, v93
    v_max3_f32 v27, v27, v94, v95
    v_max3_f32 v26, v26, v96, v97
    v_max3_f32 v27, v27, v98, v99
    v_max3_f32 v26, v26, v100, v101
    v_max3_f32 v27, v27, v102, v103
    v_max3_f32 v26, v26, v104, v105
    v_max3_f32 v27, v27, v106, v107
    s_nop 1
L_sk_45:
    s_cmp_gt_u32 s98, 4
    s_cbranch_scc1 L_sk_46
    v_mfma_f32_32x32x16_bf16 v[76:91], v[44:47], v[72:75], 0
    s_nop 11
    v_max3_f32 v26, v26, v76, v77
    v_max3_f32 v27, v27, v78, v79
    v_max3_f32 v26, v26, v80, v81
    v_max3_f32 v27, v27, v82, v83
    v_max3_f32 v26, v26, v84, v85
    v_max3_f32 v27, v27, v86, v87
    v_max3_f32 v26, v26, v88, v89
    v_max3_f32 v27, v27, v90, v91
    s_nop 1
L_sk_46:
    s_cmp_gt_u32 s98, 5
    s_cbranch_scc1 L_sk_47
    v_mfma_f32_32x32x16_bf16 v[92:107], v[48:51], v[72:75], 0
    s_nop 11
    v_max3_f32 v26, v26, v92, v93
    v_max3_f32 v27, v27, v94, v95
    v_max3_f32 v26, v26, v96, v97
    v_max3_f32 v27, v27, v98, v99
    v_max3_f32 v26, v26, v100, v101
    v_max3_f32 v27, v27, v102, v103
    v_max3_f32 v26, v26, v104, v105
    v_max3_f32 v27, v27, v106, v107
    s_nop 1
L_sk_47:
    s_cmp_gt_u32 s98, 6
    s_cbranch_scc1 L_sk_48
    v_mfma_f32_32x32x16_bf16 v[76:91], v[52:55], v[72:75], 0
    s_nop 11
    v_max3_f32 v26, v26, v76, v77
    v_max3_f32 v27, v27, v78, v79
    v_max3_f32 v26, v26, v80, v81
    v_max3_f32 v27, v27, v82, v83
    v_max3_f32 v26, v26, v84, v85
    v_max3_f32 v27, v27, v86, v87
    v_max3_f32 v26, v26, v88, v89
    v_max3_f32 v27, v27, v90, v91
    s_nop 1
L_sk_48:
    s_cmp_gt_u32 s98, 7
    s_cbranch_scc1 L_sk_49
    v_mfma_f32_32x32x16_bf16 v[92:107], v[56:59], v[72:75], 0
    s_nop 11
    v_max3_f32 v26, v26, v92, v93
    v_max3_f32 v27, v27, v94, v95
    v_max3_f32 v26, v26, v96, v97
    v_max3_f32 v27, v27, v98, v99
    v_max3_f32 v26, v26, v100, v101
    v_max3_f32 v27, v27, v102, v103
    v_max3_f32 v26, v26, v104, v105
    v_max3_f32 v27, v27, v106, v107
    s_nop 1
L_sk_49:
    v_mfma_f32_32x32x16_bf16 v[76:91], v[60:63], v[72:75], 0
    s_nop 11
    v_max3_f32 v26, v26, v76, v77
    v_max3_f32 v27, v27, v78, v79
    v_max3_f32 v26, v26, v80, v81
    v_max3_f32 v27, v27, v82, v83
    v_max3_f32 v26, v26, v84, v85
    v_max3_f32 v27, v27, v86, v87
    v_max3_f32 v26, v26, v88, v89
    v_max3_f32 v27, v27, v90, v91
    v_max_f32 v26, v26, v27
    v_mov_b32 v27, v26
    s_nop 1
    v_permlane32_swap_b32 v26, v27
    v_max_f32 v26, v26, v27
    v_sub_f32 v124, 0, v26
    v_sub_f32 v125, 0, v26
    v_sub_f32 v126, 0, v26
    v_sub_f32 v127, 0, v26
    v_sub_f32 v128, 0, v26
    v_sub_f32 v129, 0, v26
    v_sub_f32 v130, 0, v26
    v_sub_f32 v131, 0, v26
    v_sub_f32 v132, 0, v26
    v_sub_f32 v133, 0, v26
    v_sub_f32 v134, 0, v26
    v_sub_f32 v135, 0, v26
    v_sub_f32 v136, 0, v26
    v_sub_f32 v137, 0, v26
    v_sub_f32 v138, 0, v26
    v_sub_f32 v139, 0, v26
    v_add_f32 v108, v108, v124
    v_add_f32 v109, v109, v124
    v_add_f32 v110, v110, v124
    v_add_f32 v111, v111, v124
    v_add_f32 v112, v112, v124
    v_add_f32 v113, v113, v124
    v_add_f32 v114, v114, v124
    v_add_f32 v115, v115, v124
    v_add_f32 v116, v116, v124
    v_add_f32 v117, v117, v124
    v_add_f32 v118, v118, v124
    v_add_f32 v119, v119, v124
    v_add_f32 v120, v120, v124
    v_add_f32 v121, v121, v124
    v_add_f32 v122, v122, v124
    v_add_f32 v123, v123, v124
    v_exp_f32 v108, v108
    v_exp_f32 v109, v109
    v_exp_f32 v110, v110
    v_exp_f32 v111, v111
    v_exp_f32 v112, v112
    v_exp_f32 v113, v113
    v_exp_f32 v114, v114
    v_exp_f32 v115, v115
    v_exp_f32 v116, v116
    v_exp_f32 v117, v117
    v_exp_f32 v118, v118
    v_exp_f32 v119, v119
    v_exp_f32 v120, v120
    v_exp_f32 v121, v121
    v_exp_f32 v122, v122
    v_exp_f32 v123, v123
    v_cvt_pk_bf16_f32 v108, v108, v109
    v_cvt_pk_bf16_f32 v109, v110, v111
    v_cvt_pk_bf16_f32 v110, v112, v113
    v_cvt_pk_bf16_f32 v111, v114, v115
    v_cvt_pk_bf16_f32 v112, v116, v117
    v_cvt_pk_bf16_f32 v113, v118, v119
    v_cvt_pk_bf16_f32 v114, v120, v121
    v_cvt_pk_bf16_f32 v115, v122, v123
    v_and_b32 v116, v108, v15
    v_and_b32 v117, v109, v16
    v_and_b32 v118, v110, v17
    v_and_b32 v119, v111, v18
    v_and_b32 v120, v112, v19
    v_and_b32 v121, v113, v20
    v_and_b32 v122, v114, v21
    v_and_b32 v123, v115, v22
    v_xor_b32 v108, v108, v116
    v_xor_b32 v109, v109, v117
    v_xor_b32 v110, v110, v118
    v_xor_b32 v111, v111, v119
    v_xor_b32 v112, v112, v120
    v_xor_b32 v113, v113, v121
    v_xor_b32 v114, v114, v122
    v_xor_b32 v115, v115, v123
    v_mfma_f32_32x32x16_bf16 v[140:155], v[244:247], v[116:119], 0
    v_mfma_f32_32x32x16_bf16 v[140:155], v[248:251], v[120:123], v[140:155]
    s_nop 11
    s_cmp_gt_u32 s98, 1
    s_cbranch_scc1 L_sk_50
    v_mfma_f32_32x32x16_bf16 v[140:155], v[180:183], v[108:111], v[140:155]
    v_mfma_f32_32x32x16_bf16 v[140:155], v[184:187], v[112:115], v[140:155]
    s_nop 11
L_sk_50:
    s_cmp_gt_u32 s98, 2
    s_cbranch_scc1 L_sk_51
    v_mfma_f32_32x32x16_bf16 v[76:91], v[36:39], v[72:75], v[124:139]
    s_nop 11
    v_exp_f32 v76, v76
    v_exp_f32 v77, v77
    v_exp_f32 v78, v78
    v_exp_f32 v79, v79
    v_exp_f32 v80, v80
    v_exp_f32 v81, v81
    v_exp_f32 v82, v82
    v_exp_f32 v83, v83
    v_exp_f32 v84, v84
    v_exp_f32 v85, v85
    v_exp_f32 v86, v86
    v_exp_f32 v87, v87
    v_exp_f32 v88, v88
    v_exp_f32 v89, v89
    v_exp_f32 v90, v90
    v_exp_f32 v91, v91
    v_cvt_pk_bf16_f32 v156, v76, v77
    v_cvt_pk_bf16_f32 v157, v78, v79
    v_cvt_pk_bf16_f32 v158, v80, v81
    v_cvt_pk_bf16_f32 v159, v82, v83
    v_cvt_pk_bf16_f32 v160, v84, v85
    v_cvt_pk_bf16_f32 v161, v86, v87
    v_cvt_pk_bf16_f32 v162, v88, v89
    v_cvt_pk_bf16_f32 v163, v90, v91
    v_mfma_f32_32x32x16_bf16 v[140:155], v[188:191], v[156:159], v[140:155]
    s_nop 0
    v_mfma_f32_32x32x16_bf16 v[140:155], v[192:195], v[160:163], v[140:155]
    s_nop 11
L_sk_51:
    s_cmp_gt_u32 s98, 3
    s_cbranch_scc1 L_sk_52
    v_mfma_f32_32x32x16_bf16 v[92:107], v[40:43], v[72:75], v[124:139]
    s_nop 11
    v_exp_f32 v92, v92
    v_exp_f32 v93, v93
    v_exp_f32 v94, v94
    v_exp_f32 v95, v95
    v_exp_f32 v96, v96
    v_exp_f32 v97, v97
    v_exp_f32 v98, v98
    v_exp_f32 v99, v99
    v_exp_f32 v100, v100
    v_exp_f32 v101, v101
    v_exp_f32 v102, v102
    v_exp_f32 v103, v103
    v_exp_f32 v104, v104
    v_exp_f32 v105, v105
    v_exp_f32 v106, v106
    v_exp_f32 v107, v107
    v_cvt_pk_bf16_f32 v164, v92, v93
    v_cvt_pk_bf16_f32 v165, v94, v95
    v_cvt_pk_bf16_f32 v166, v96, v97
    v_cvt_pk_bf16_f32 v167, v98, v99
    v_cvt_pk_bf16_f32 v168, v100, v101
    v_cvt_pk_bf16_f32 v169, v102, v103
    v_cvt_pk_bf16_f32 v170, v104, v105
    v_cvt_pk_bf16_f32 v171, v106, v107
    v_mfma_f32_32x32x16_bf16 v[140:155], v[196:199], v[164:167], v[140:155]
    s_nop 0
    v_mfma_f32_32x32x16_bf16 v[140:155], v[200:203], v[168:171], v[140:155]
    s_nop 11
L_sk_52:
    s_cmp_gt_u32 s98, 4
    s_cbranch_scc1 L_sk_53
    v_mfma_f32_32x32x16_bf16 v[76:91], v[44:47], v[72:75], v[124:139]
    s_nop 11
    v_exp_f32 v76, v76
    v_exp_f32 v77, v77
    v_exp_f32 v78, v78
    v_exp_f32 v79, v79
    v_exp_f32 v80, v80
    v_exp_f32 v81, v81
    v_exp_f32 v82, v82
    v_exp_f32 v83, v83
    v_exp_f32 v84, v84
    v_exp_f32 v85, v85
    v_exp_f32 v86, v86
    v_exp_f32 v87, v87
    v_exp_f32 v88, v88
    v_exp_f32 v89, v89
    v_exp_f32 v90, v90
    v_exp_f32 v91, v91
    v_cvt_pk_bf16_f32 v156, v76, v77
    v_cvt_pk_bf16_f32 v157, v78, v79
    v_cvt_pk_bf16_f32 v158, v80, v81
    v_cvt_pk_bf16_f32 v159, v82, v83
    v_cvt_pk_bf16_f32 v160, v84, v85
    v_cvt_pk_bf16_f32 v161, v86, v87
    v_cvt_pk_bf16_f32 v162, v88, v89
    v_cvt_pk_bf16_f32 v163, v90, v91
    v_mfma_f32_32x32x16_bf16 v[140:155], v[204:207], v[156:159], v[140:155]
    s_nop 0
    v_mfma_f32_32x32x16_bf16 v[140:155], v[208:211], v[160:163], v[140:155]
    s_nop 11
L_sk_53:
    s_cmp_gt_u32 s98, 5
    s_cbranch_scc1 L_sk_54
    v_mfma_f32_32x32x16_bf16 v[92:107], v[48:51], v[72:75], v[124:139]
    s_nop 11
    v_exp_f32 v92, v92
    v_exp_f32 v93, v93
    v_exp_f32 v94, v94
    v_exp_f32 v95, v95
    v_exp_f32 v96, v96
    v_exp_f32 v97, v97
    v_exp_f32 v98, v98
    v_exp_f32 v99, v99
    v_exp_f32 v100, v100
    v_exp_f32 v101, v101
    v_exp_f32 v102, v102
    v_exp_f32 v103, v103
    v_exp_f32 v104, v104
    v_exp_f32 v105, v105
    v_exp_f32 v106, v106
    v_exp_f32 v107, v107
    v_cvt_pk_bf16_f32 v164, v92, v93
    v_cvt_pk_bf16_f32 v165, v94, v95
    v_cvt_pk_bf16_f32 v166, v96, v97
    v_cvt_pk_bf16_f32 v167, v98, v99
    v_cvt_pk_bf16_f32 v168, v100, v101
    v_cvt_pk_bf16_f32 v169, v102, v103
    v_cvt_pk_bf16_f32 v170, v104, v105
    v_cvt_pk_bf16_f32 v171, v106, v107
    v_mfma_f32_32x32x16_bf16 v[140:155], v[212:215], v[164:167], v[140:155]
    s_nop 0
    v_mfma_f32_32x32x16_bf16 v[140:155], v[216:219], v[168:171], v[140:155]
    s_nop 11
L_sk_54:
    s_cmp_gt_u32 s98, 6
    s_cbranch_scc1 L_sk_55
    v_mfma_f32_32x32x16_bf16 v[76:91], v[52:55], v[72:75], v[124:139]
    s_nop 11
    v_exp_f32 v76, v76
    v_exp_f32 v77, v77
    v_exp_f32 v78, v78
    v_exp_f32 v79, v79
    v_exp_f32 v80, v80
    v_exp_f32 v81, v81
    v_exp_f32 v82, v82
    v_exp_f32 v83, v83
    v_exp_f32 v84, v84
    v_exp_f32 v85, v85
    v_exp_f32 v86, v86
    v_exp_f32 v87, v87
    v_exp_f32 v88, v88
    v_exp_f32 v89, v89
    v_exp_f32 v90, v90
    v_exp_f32 v91, v91
    v_cvt_pk_bf16_f32 v156, v76, v77
    v_cvt_pk_bf16_f32 v157, v78, v79
    v_cvt_pk_bf16_f32 v158, v80, v81
    v_cvt_pk_bf16_f32 v159, v82, v83
    v_cvt_pk_bf16_f32 v160, v84, v85
    v_cvt_pk_bf16_f32 v161, v86, v87
    v_cvt_pk_bf16_f32 v162, v88, v89
    v_cvt_pk_bf16_f32 v163, v90, v91
    v_mfma_f32_32x32x16_bf16 v[140:155], v[220:223], v[156:159], v[140:155]
    s_nop 0
    v_mfma_f32_32x32x16_bf16 v[140:155], v[224:227], v[160:163], v[140:155]
    s_nop 11
L_sk_55:
    s_cmp_gt_u32 s98, 7
    s_cbranch_scc1 L_sk_56
    v_mfma_f32_32x32x16_bf16 v[92:107], v[56:59], v[72:75], v[124:139]
    s_nop 11
    v_exp_f32 v92, v92
    v_exp_f32 v93, v93
    v_exp_f32 v94, v94
    v_exp_f32 v95, v95
    v_exp_f32 v96, v96
    v_exp_f32 v97, v97
    v_exp_f32 v98, v98
    v_exp_f32 v99, v99
    v_exp_f32 v100, v100
    v_exp_f32 v101, v101
    v_exp_f32 v102, v102
    v_exp_f32 v103, v103
    v_exp_f32 v104, v104
    v_exp_f32 v105, v105
    v_exp_f32 v106, v106
    v_exp_f32 v107, v107
    v_cvt_pk_bf16_f32 v164, v92, v93
    v_cvt_pk_bf16_f32 v165, v94, v95
    v_cvt_pk_bf16_f32 v166, v96, v97
    v_cvt_pk_bf16_f32 v167, v98, v99
    v_cvt_pk_bf16_f32 v168, v100, v101
    v_cvt_pk_bf16_f32 v169, v102, v103
    v_cvt_pk_bf16_f32 v170, v104, v105
    v_cvt_pk_bf16_f32 v171, v106, v107
    v_mfma_f32_32x32x16_bf16 v[140:155], v[228:231], v[164:167], v[140:155]
    s_nop 0
    v_mfma_f32_32x32x16_bf16 v[140:155], v[232:235], v[168:171], v[140:155]
    s_nop 11
L_sk_56:
    v_mfma_f32_32x32x16_bf16 v[76:91], v[60:63], v[72:75], v[124:139]
    s_nop 11
    v_exp_f32 v76, v76
    v_exp_f32 v77, v77
    v_exp_f32 v78, v78
    v_exp_f32 v79, v79
    v_exp_f32 v80, v80
    v_exp_f32 v81, v81
    v_exp_f32 v82, v82
    v_exp_f32 v83, v83
    v_exp_f32 v84, v84
    v_exp_f32 v85, v85
    v_exp_f32 v86, v86
    v_exp_f32 v87, v87
    v_exp_f32 v88, v88
    v_exp_f32 v89, v89
    v_exp_f32 v90, v90
    v_exp_f32 v91, v91
    v_cvt_pk_bf16_f32 v156, v76, v77
    v_cvt_pk_bf16_f32 v157, v78, v79
    v_cvt_pk_bf16_f32 v158, v80, v81
    v_cvt_pk_bf16_f32 v159, v82, v83
    v_cvt_pk_bf16_f32 v160, v84, v85
    v_cvt_pk_bf16_f32 v161, v86, v87
    v_cvt_pk_bf16_f32 v162, v88, v89
    v_cvt_pk_bf16_f32 v163, v90, v91
    v_mfma_f32_32x32x16_bf16 v[140:155], v[236:239], v[156:159], v[140:155]
    s_nop 0
    v_mfma_f32_32x32x16_bf16 v[140:155], v[240:243], v[160:163], v[140:155]
    s_nop 11
    v_rcp_f32 v26, v148
    s_nop 0
    v_mul_f32 v26, v26, v25
    v_mul_f32 v140, v140, v26
    v_mul_f32 v141, v141, v26
    v_mul_f32 v142, v142, v26
    v_mul_f32 v143, v143, v26
    v_mul_f32 v144, v144, v26
    v_mul_f32 v145, v145, v26
    v_mul_f32 v146, v146, v26
    v_mul_f32 v147, v147, v26
    v_cvt_pk_bf16_f32 v124, v140, v141
    v_cvt_pk_bf16_f32 v125, v142, v143
    v_cvt_pk_bf16_f32 v126, v144, v145
    v_cvt_pk_bf16_f32 v127, v146, v147
    s_add_u32 s59, s57, 1
    s_mul_i32 s59, s59, 144
    s_add_u32 s59, s59, s56
    s_add_u32 s59, s59, 112
    s_lshl_b32 s59, s59, 10
    s_add_u32 s59, s59, 8388608
    buffer_store_dwordx4 v[124:127], v2, s[36:39], s59 offen sc1
    s_branch L_att_pub
L_n_3:
    global_load_dword v23, v3, s[24:25] sc1
    s_waitcnt vmcnt(0)
    v_readfirstlane_b32 s58, v23
    s_sub_u32 s99, s99, 1
    s_cmp_eq_u32 s99, 0
    s_cbranch_scc1 L_nk_4
    s_cmp_lg_u32 s58, 0
    s_cbranch_scc1 L_nk_4
    s_branch L_n_3
L_lw_5:
    s_sleep 2
    ds_read_b32 v4, v12 offset:0
    s_sub_u32 s99, s99, 1
    s_waitcnt lgkmcnt(0)
    s_cbranch_scc1 L_lo_6
    v_readfirstlane_b32 s59, v4
    s_nop 0
    s_cmp_lt_u32 s59, 4
    s_cbranch_scc1 L_lw_5
    s_branch L_lo_6
L_lw_7:
    s_sleep 2
    ds_read_b32 v4, v12 offset:8
    s_sub_u32 s99, s99, 1
    s_waitcnt lgkmcnt(0)
    s_cbranch_scc1 L_lo_8
    v_readfirstlane_b32 s59, v4
    s_nop 0
    s_cmp_lt_u32 s59, 8
    s_cbranch_scc1 L_lw_7
    s_branch L_lo_8
L_lw_9:
    s_sleep 2
    ds_read_b32 v5, v4 offset:16
    s_sub_u32 s99, s99, 1
    s_waitcnt lgkmcnt(0)
    s_cbranch_scc1 L_lo_10
    v_readfirstlane_b32 s59, v5
    s_nop 0
    s_cmp_lt_u32 s59, 1
    s_cbranch_scc1 L_lw_9
    s_branch L_lo_10
L_poll_11:
    s_sleep 2
    s_mov_b32 s92, 0
    s_atomic_add s92, s[74:75], 0 glc
    s_mov_b32 s93, 0
    s_atomic_add s93, s[74:75], 256 glc
    s_mov_b32 s94, 0
    s_atomic_add s94, s[74:75], 512 glc
    s_mov_b32 s95, 0
    s_atomic_add s95, s[74:75], 768 glc
    s_sub_u32 s99, s99, 1
    s_waitcnt lgkmcnt(0)
    s_cbranch_scc1 L_pout_12
    s_xor_b32 s92, s92, s58
    s_xor_b32 s93, s93, s58
    s_xor_b32 s94, s94, s58
    s_xor_b32 s95, s95, s58
    s_or_b32 s92, s92, s93
    s_or_b32 s92, s92, s94
    s_or_b32 s92, s92, s95
    s_cbranch_scc1 L_poll_11
    s_branch L_pout_12
L_poll_13:
    s_sleep 2
    s_mov_b32 s92, 0
    s_atomic_add s92, s[74:75], 65536 glc
    s_mov_b32 s93, 0
    s_atomic_add s93, s[74:75], 65792 glc
    s_mov_b32 s94, 0
    s_atomic_add s94, s[74:75], 66048 glc
    s_mov_b32 s95, 0
    s_atomic_add s95, s[74:75], 66304 glc
    s_sub_u32 s99, s99, 1
    s_waitcnt lgkmcnt(0)
    s_cbranch_scc1 L_pout_14
    s_xor_b32 s92, s92, s58
    s_xor_b32 s93, s93, s58
    s_xor_b32 s94, s94, s58
    s_xor_b32 s95, s95, s58
    s_or_b32 s92, s92, s93
    s_or_b32 s92, s92, s94
    s_or_b32 s92, s92, s95
    s_cbranch_scc1 L_poll_13
    s_branch L_pout_14
L_n_17:
    global_load_dword v36, v3, s[24:25] sc1
    s_waitcnt vmcnt(0)
    v_readfirstlane_b32 s58, v36
    s_sub_u32 s99, s99, 1
    s_cmp_eq_u32 s99, 0
    s_cbranch_scc1 L_nk_18
    s_cmp_lg_u32 s58, 0
    s_cbranch_scc1 L_nk_18
    s_branch L_n_17
L_lw_19:
    s_sleep 2
    ds_read_b32 v23, v8 offset:4
    s_sub_u32 s99, s99, 1
    s_waitcnt lgkmcnt(0)
    s_cbranch_scc1 L_lo_20
    v_readfirstlane_b32 s59, v23
    s_nop 0
    s_cmp_lt_u32 s59, 4
    s_cbranch_scc1 L_lw_19
    s_branch L_lo_20
L_poll_21:
    s_sleep 2
    s_mov_b32 s19, 0
    s_atomic_add s19, s[26:27], s4 glc
    s_mov_b32 s22, 0
    s_atomic_add s22, s[26:27], s5 glc
    s_mov_b32 s23, 0
    s_atomic_add s23, s[26:27], s6 glc
    s_mov_b32 s60, 0
    s_atomic_add s60, s[26:27], s7 glc
    s_mov_b32 s61, 0
    s_atomic_add s61, s[26:27], s8 glc
    s_mov_b32 s62, 0
    s_atomic_add s62, s[26:27], s9 glc
    s_mov_b32 s63, 0
    s_atomic_add s63, s[26:27], s18 glc
    s_sub_u32 s99, s99, 1
    s_waitcnt lgkmcnt(0)
    s_cbranch_scc1 L_pout_22
    s_xor_b32 s19, s19, s58
    s_xor_b32 s22, s22, s58
    s_xor_b32 s23, s23, s58
    s_xor_b32 s60, s60, s58
    s_xor_b32 s61, s61, s58
    s_xor_b32 s62, s62, s58
    s_xor_b32 s63, s63, s58
    s_or_b32 s19, s19, s22
    s_or_b32 s19, s19, s23
    s_or_b32 s19, s19, s60
    s_or_b32 s19, s19, s61
    s_or_b32 s19, s19, s62
    s_or_b32 s19, s19, s63
    s_cbranch_scc1 L_poll_21
    s_branch L_pout_22
L_lw_23:
    s_sleep 2
    ds_read_b32 v23, v8 offset:32
    s_sub_u32 s99, s99, 1
    s_waitcnt lgkmcnt(0)
    s_cbranch_scc1 L_lo_24
    v_readfirstlane_b32 s59, v23
    s_nop 0
    s_cmp_lt_u32 s59, 1
    s_cbranch_scc1 L_lw_23
    s_branch L_lo_24
L_lw_25:
    s_sleep 2
    ds_read_b32 v23, v8 offset:12
    s_sub_u32 s99, s99, 1
    s_waitcnt lgkmcnt(0)
    s_cbranch_scc1 L_lo_26
    v_readfirstlane_b32 s59, v23
    s_nop 0
    s_cmp_lt_u32 s59, 4
    s_cbranch_scc1 L_lw_25
    s_branch L_lo_26
L_end:
    s_endpgm
.section .rodata,"a"
.p2align 6
.amdhsa_kernel gated_mix__sliding_block__mixer_channel_mlp__prompt_kernel
  .amdhsa_next_free_vgpr 256
  .amdhsa_next_free_sgpr 102
  .amdhsa_accum_offset 256
  .amdhsa_group_segment_fixed_size 0
  .amdhsa_kernarg_size 96
  .amdhsa_user_sgpr_count 2
  .amdhsa_user_sgpr_kernarg_segment_ptr 1
  .amdhsa_system_sgpr_workgroup_id_x 1
.end_amdhsa_kernel
```
